```python
import torch

def _softmax(x, axis=-1):
    return torch.softmax(x, dim=axis)
def _gelu(x):
    return torch.nn.functional.gelu(x, approximate="tanh")
def _silu(x):
    return torch.nn.functional.silu(x)
def _sigmoid(x):
    return torch.sigmoid(x)
def _layernorm(x, axis=-1, eps=1e-5):
    m = x.mean(dim=axis, keepdim=True)
    v = x.var(dim=axis, keepdim=True, unbiased=False)
    return (x - m) / torch.sqrt(v + eps)
def _scatter_add(tgt, idx, src, axis=0):
    return tgt.clone().index_add_(axis, idx, src)
def _segment_sum(src, seg, n):
    out = torch.zeros((n,) + src.shape[1:], dtype=src.dtype)
    return out.index_add_(0, seg, src)
def _pad(x, pw):
    flat = tuple(v for pair in reversed(pw) for v in pair)
    return torch.nn.functional.pad(x, flat)

kernel_name = 'parallel_sum__mha_block__moe_arch_mod__prompt'

def setup_inputs():

    _w = (lambda a: (lambda t: t.to(torch.bfloat16) if t.is_floating_point() else t)(torch.as_tensor(a)))
    def _A_setup():
        B, S, D, H = 1, 2048, 640, 32
        return {
            "x": _w((lambda *s: torch.randn(*s, dtype=torch.bfloat16) * 0.05)(B, S, D)),
            "wqkv": _w((lambda *s: torch.randn(*s, dtype=torch.bfloat16) * 0.1)(D, 3 * D)),
            "wo": _w((lambda *s: torch.randn(*s, dtype=torch.bfloat16) * 0.05)(D, D)),
        }
    _A_in = _A_setup()

    def _B_setup():
        B, S, D, F, C = 1, 2048, 640, 1536, 2
        return {
            "x": _w((lambda *s: torch.randn(*s, dtype=torch.bfloat16) * 0.05)(B, S, D)),
            "w_r": _w((lambda *s: torch.randn(*s, dtype=torch.bfloat16) * 3.2)(D)),
            "w_gate": _w((lambda *s: torch.randn(*s, dtype=torch.bfloat16) * 0.1)(D, F)),
            "w_up": _w((lambda *s: torch.randn(*s, dtype=torch.bfloat16) * 0.1)(D, F)),
            "w_down": _w((lambda *s: torch.randn(*s, dtype=torch.bfloat16) * 0.1)(F, D)),
        }
    _B_in = _B_setup()

    return {
        "A_x": _A_in["x"],
        "A_wqkv": _A_in["wqkv"],
        "A_wo": _A_in["wo"],
        "B_x": _B_in["x"],
        "B_w_r": _B_in["w_r"],
        "B_w_gate": _B_in["w_gate"],
        "B_w_up": _B_in["w_up"],
        "B_w_down": _B_in["w_down"],
    }

def reference(A_x, A_wqkv, A_wo, B_x, B_w_r, B_w_gate, B_w_up, B_w_down):
    def _A_ref(x, wqkv, wo):
        B, S, D = x.shape
        H = 32
        Dh = D // H
        qkv = (lambda x, *d: x.permute(*d))((x @ wqkv).reshape(B, S, 3, H, Dh), 2, 0, 3, 1, 4)
        q, k, v = qkv[0], qkv[1], qkv[2]
        scores = torch.einsum("bhqd,bhkd->bhqk", q, k) * (Dh ** -0.5)
        p = _softmax(scores, axis=-1)
        o = torch.einsum("bhqk,bhkd->bhqd", p, v)
        return (lambda x, *d: x.permute(*d))(o, 0, 2, 1, 3).reshape(B, S, D) @ wo

    def _B_ref(x, w_r, w_gate, w_up, w_down):
        B, S, D = x.shape
        C = 2
        r = x @ w_r
        idx = torch.argsort(-r, axis=-1)[:, :C]
        idx_e = (lambda x, n, axis: torch.repeat_interleave(x, n, dim=axis))(idx.reshape(B, C, 1), D, axis=2)
        x_sel = (lambda x, i, axis: torch.take_along_dim(x, i, dim=axis))(x, idx_e, axis=1)
        g = _silu(x_sel @ w_gate)
        u = x_sel @ w_up
        y = (g * u) @ w_down
        r_sel = _sigmoid((lambda x, i, axis: torch.take_along_dim(x, i, dim=axis))(r, idx, axis=1))
        y = y * r_sel.reshape(B, C, 1)
        b_off = (torch.arange(B) * S).reshape(B, 1)
        flat_idx = (idx + b_off).reshape(B * C)
        zero = (x * 0.0).reshape(B * S, D)
        upd = _scatter_add(zero, flat_idx, y.reshape(B * C, D), axis=0)
        return x + upd.reshape(B, S, D)

    x = A_x
    xn = _layernorm(x, axis=-1)
    return x + _A_ref(xn, A_wqkv, A_wo) + _B_ref(xn, B_w_r, B_w_gate, B_w_up, B_w_down)
```

```asm
; @launch grid=(256,1,1) block=(384,1,1) lds=163840
.amdgcn_target "amdgcn-amd-amdhsa--gfx950"
.text
.globl parallel_sum__mha_block__moe_arch_mod__prompt_kernel
.p2align 8
.type parallel_sum__mha_block__moe_arch_mod__prompt_kernel,@function
parallel_sum__mha_block__moe_arch_mod__prompt_kernel:
    s_cmp_ge_u32 s2, 256
    s_cbranch_scc1 L_end
    s_load_dwordx4 s[4:7], s[0:1], 0
    s_load_dwordx2 s[8:9], s[0:1], 16
    s_load_dwordx8 s[12:19], s[0:1], 32
    s_load_dwordx4 s[20:23], s[0:1], 64
    s_load_dwordx2 s[24:25], s[0:1], 80
    v_lshrrev_b32 v1, 6, v0
    v_and_b32 v255, 63, v0
    v_readfirstlane_b32 s3, v1
    s_and_b32 s29, s2, 7
    s_lshr_b32 s30, s2, 3
    s_and_b32 s27, s29, 3
    s_lshl_b32 s27, s27, 2
    s_and_b32 s31, s30, 3
    s_add_u32 s27, s27, s31
    s_lshr_b32 s30, s30, 2
    s_lshr_b32 s29, s29, 2
    s_mul_i32 s28, s29, 7
    s_add_u32 s28, s28, s30
    s_lshr_b32 s31, s31, 1
    s_xor_b32 s31, s31, s29
    s_cmp_eq_u32 s28, 7
    s_cselect_b32 s31, s31, 0
    s_cmp_lg_u32 s31, 0
    s_cselect_b32 s28, 15, s28
    s_cmp_lt_u32 s3, 4
    s_cbranch_scc1 L_compute
    s_getpc_b64 s[56:57]
    s_and_b32 s56, s56, 0xffffff00
    s_sub_u32 s56, s56, 0x0
    s_subb_u32 s57, s57, 0
    s_lshr_b32 s30, s2, 3
    s_and_b32 s30, s30, 3
    s_lshl_b32 s30, s30, 1
    s_sub_u32 s31, s3, 4
    s_add_u32 s30, s30, s31
    s_lshl_b32 s30, s30, 13
    v_lshlrev_b32 v3, 7, v255
    v_add_u32 v3, s30, v3
    v_cmp_gt_u32 vcc, 0x94c8, v3
    s_and_saveexec_b64 s[58:59], vcc
    s_cbranch_execz L_nopf1
    global_load_dword v250, v3, s[56:57]
L_nopf1:
    s_mov_b64 exec, s[58:59]
    s_waitcnt lgkmcnt(0)
    s_cmp_ge_u32 s28, 15
    s_cbranch_scc1 L_h_idle
    s_cmp_eq_u32 s3, 4
    s_cbranch_scc0 L_ld_w
    s_mov_b32 s32, s4
    s_mov_b32 s33, s5
    s_mov_b32 s34, 0x280000
    s_mov_b32 s35, 0x00020000
    v_lshrrev_b32 v3, 3, v255
    v_mul_u32_u24 v3, 1280, v3
    v_lshrrev_b32 v4, 4, v255
    v_and_b32 v5, 7, v255
    v_xor_b32 v5, v5, v4
    v_lshl_add_u32 v20, v5, 4, v3
    v_xor_b32 v21, 64, v20
    s_lshl_b32 s29, s27, 7
    s_mul_i32 s56, s29, 1280
    s_mov_b32 s58, 10240
    s_mov_b32 s59, 128
    s_mov_b32 s64, 0
    s_branch L_ld_go
L_ld_w:
    s_mov_b32 s32, s6
    s_mov_b32 s33, s7
    s_mov_b32 s34, 0x258000
    s_mov_b32 s35, 0x00020000
    v_lshrrev_b32 v4, 4, v255
    v_and_b32 v5, 15, v255
    v_lshlrev_b32 v6, 2, v4
    v_xor_b32 v5, v5, v6
    v_mul_u32_u24 v7, 3840, v4
    v_lshl_add_u32 v20, v5, 4, v7
    v_mov_b32 v21, v20
    s_lshl_b32 s56, s28, 8
    s_mov_b32 s58, 15360
    s_mov_b32 s59, 245760
    s_mov_b32 s64, 16384
L_ld_go:
    s_mov_b32 s61, 0
    s_mov_b32 s63, 0
L_ld_loop:
    s_cmp_lt_u32 s61, 2
    s_cbranch_scc1 L_ld_issue
    s_waitcnt vmcnt(16)
    s_barrier
    s_cmp_eq_u32 s61, 7
    s_cbranch_scc0 L_ld_issue
    v_mov_b32 v10, 163328
    ds_read_b32 v11, v10
    s_waitcnt lgkmcnt(0)
    v_readfirstlane_b32 s26, v11
L_ld_issue:
    s_add_u32 s65, s63, s64
    s_mov_b32 s57, s56
    s_add_u32 m0, s65, 0
    s_nop 0
    buffer_load_dwordx4 v20, s[32:35], s57 offen lds
    s_add_u32 m0, s65, 1024
    s_add_u32 s57, s57, s58
    buffer_load_dwordx4 v21, s[32:35], s57 offen lds
    s_add_u32 m0, s65, 2048
    s_add_u32 s57, s57, s58
    buffer_load_dwordx4 v20, s[32:35], s57 offen lds
    s_add_u32 m0, s65, 3072
    s_add_u32 s57, s57, s58
    buffer_load_dwordx4 v21, s[32:35], s57 offen lds
    s_add_u32 m0, s65, 4096
    s_add_u32 s57, s57, s58
    buffer_load_dwordx4 v20, s[32:35], s57 offen lds
    s_add_u32 m0, s65, 5120
    s_add_u32 s57, s57, s58
    buffer_load_dwordx4 v21, s[32:35], s57 offen lds
    s_add_u32 m0, s65, 6144
    s_add_u32 s57, s57, s58
    buffer_load_dwordx4 v20, s[32:35], s57 offen lds
    s_add_u32 m0, s65, 7168
    s_add_u32 s57, s57, s58
    buffer_load_dwordx4 v21, s[32:35], s57 offen lds
    s_add_u32 m0, s65, 8192
    s_add_u32 s57, s57, s58
    buffer_load_dwordx4 v20, s[32:35], s57 offen lds
    s_add_u32 m0, s65, 9216
    s_add_u32 s57, s57, s58
    buffer_load_dwordx4 v21, s[32:35], s57 offen lds
    s_add_u32 m0, s65, 10240
    s_add_u32 s57, s57, s58
    buffer_load_dwordx4 v20, s[32:35], s57 offen lds
    s_add_u32 m0, s65, 11264
    s_add_u32 s57, s57, s58
    buffer_load_dwordx4 v21, s[32:35], s57 offen lds
    s_add_u32 m0, s65, 12288
    s_add_u32 s57, s57, s58
    buffer_load_dwordx4 v20, s[32:35], s57 offen lds
    s_add_u32 m0, s65, 13312
    s_add_u32 s57, s57, s58
    buffer_load_dwordx4 v21, s[32:35], s57 offen lds
    s_add_u32 m0, s65, 14336
    s_add_u32 s57, s57, s58
    buffer_load_dwordx4 v20, s[32:35], s57 offen lds
    s_add_u32 m0, s65, 15360
    s_add_u32 s57, s57, s58
    buffer_load_dwordx4 v21, s[32:35], s57 offen lds
    s_add_u32 s56, s56, s59
    s_add_u32 s63, s63, 32768
    s_and_b32 s63, s63, 131071
    s_add_u32 s61, s61, 1
    s_cmp_lt_u32 s61, 10
    s_cbranch_scc1 L_ld_loop
    s_branch L_helper
L_compute:
    v_mov_b32 v10, 163328
    v_mov_b32 v12, 0
    v_mov_b32 v13, 0
    v_mov_b32 v14, 0
    v_mov_b32 v15, 0
    ds_write_b128 v10, v[12:15]
    v_and_b32 v3, 31, v255
    v_lshrrev_b32 v4, 5, v255
    v_lshrrev_b32 v5, 1, v3
    v_and_b32 v5, 7, v5
    s_and_b32 s29, s3, 1
    s_lshl_b32 s29, s29, 13
    v_lshlrev_b32 v6, 7, v3
    v_add_u32 v6, s29, v6
    v_add_u32 v7, 0, v4
    v_xor_b32 v7, v7, v5
    v_lshl_add_u32 v8, v7, 4, v6
    v_add_u32 v12, 0x10000, v8
    v_add_u32 v7, 2, v4
    v_xor_b32 v7, v7, v5
    v_lshl_add_u32 v9, v7, 4, v6
    v_add_u32 v13, 0x10000, v9
    v_add_u32 v7, 4, v4
    v_xor_b32 v7, v7, v5
    v_lshl_add_u32 v10, v7, 4, v6
    v_add_u32 v14, 0x10000, v10
    v_add_u32 v7, 6, v4
    v_xor_b32 v7, v7, v5
    v_lshl_add_u32 v11, v7, 4, v6
    v_add_u32 v15, 0x10000, v11
    v_lshrrev_b32 v5, 4, v255
    v_and_b32 v5, 1, v5
    v_and_b32 v6, 3, v255
    v_lshl_add_u32 v5, v5, 2, v6
    v_bfe_u32 v6, v255, 2, 2
    v_lshl_add_u32 v7, v4, 3, v6
    v_lshlrev_b32 v7, 8, v7
    v_add_u32 v7, 16384, v7
    v_and_b32 v28, 4, v5
    v_and_b32 v29, 1, v5
    v_lshl_or_b32 v28, v29, 1, v28
    v_bfe_u32 v29, v5, 1, 1
    v_or_b32 v28, v28, v29
    s_cmp_ge_u32 s28, 10
    s_cselect_b64 vcc, -1, 0
    s_lshr_b32 s29, s3, 1
    s_lshl_b32 s29, s29, 4
    v_cndmask_b32 v28, v28, v5, vcc
    v_add_u32 v28, s29, v28
    v_add_u32 v29, 0, v28
    v_lshrrev_b32 v30, 1, v29
    v_lshlrev_b32 v31, 2, v6
    v_xor_b32 v30, v30, v31
    v_and_b32 v29, 1, v29
    v_lshlrev_b32 v29, 3, v29
    v_lshl_add_u32 v29, v30, 4, v29
    v_add_u32 v16, v29, v7
    v_add_u32 v18, 0x10000, v16
    v_add_u32 v29, 8, v28
    v_lshrrev_b32 v30, 1, v29
    v_lshlrev_b32 v31, 2, v6
    v_xor_b32 v30, v30, v31
    v_and_b32 v29, 1, v29
    v_lshlrev_b32 v29, 3, v29
    v_lshl_add_u32 v29, v30, 4, v29
    v_add_u32 v17, v29, v7
    v_add_u32 v19, 0x10000, v17
    s_waitcnt lgkmcnt(0)
    s_or_b32 s29, s2, s3
    s_cmp_lg_u32 s29, 0
    s_cbranch_scc1 L_nononce
    s_mov_b32 s52, s22
    s_mov_b32 s53, s23
    s_mov_b32 s54, 0x100
    s_mov_b32 s55, 0x00020000
    s_memrealtime s[30:31]
    s_waitcnt lgkmcnt(0)
    s_or_b32 s30, s30, 1
    v_mov_b32 v24, 0
    v_mov_b32 v25, s30
    buffer_store_dword v25, v24, s[52:55], 0 offen sc1
L_nononce:
    s_mov_b32 s32, s4
    s_mov_b32 s33, s5
    s_mov_b32 s34, 0x280000
    s_mov_b32 s35, 0x00020000
    s_mov_b32 s36, s12
    s_mov_b32 s37, s13
    s_mov_b32 s38, 0x500
    s_mov_b32 s39, 0x00020000
    s_mov_b32 s40, s6
    s_mov_b32 s41, s7
    s_mov_b32 s42, 0x258000
    s_mov_b32 s43, 0x00020000
    s_mov_b32 s52, s22
    s_mov_b32 s53, s23
    s_mov_b32 s54, 0x100
    s_mov_b32 s55, 0x00020000
    v_and_b32 v3, 31, v255
    v_lshrrev_b32 v4, 5, v255
    s_and_b32 s29, s2, 3
    s_lshl_b32 s29, s29, 9
    s_and_b32 s30, s2, 4
    s_lshl_b32 s30, s30, 6
    s_add_u32 s29, s29, s30
    s_and_b32 s30, s2, 0xf8
    s_add_u32 s29, s29, s30
    s_lshl_b32 s30, s3, 1
    s_add_u32 s29, s29, s30
    v_add_u32 v164, s29, v4
    v_mul_u32_u24 v6, 1280, v164
    v_lshlrev_b32 v7, 4, v3
    v_lshlrev_b32 v24, 3, v3
    v_add_u32 v24, 1024, v24
    v_add_u32 v25, v6, v7
    v_add_u32 v26, v6, v24
    buffer_load_dwordx4 v[190:193], v25, s[32:35], 0 offen
    buffer_load_dwordx4 v[194:197], v25, s[32:35], 0 offen offset:512
    buffer_load_dwordx2 v[198:199], v26, s[32:35], 0 offen
    buffer_load_dwordx4 v[200:203], v7, s[36:39], 0 offen
    buffer_load_dwordx4 v[204:207], v7, s[36:39], 0 offen offset:512
    buffer_load_dwordx2 v[208:209], v24, s[36:39], 0 offen
    v_lshlrev_b32 v25, 2, v255
    s_mul_i32 s29, s27, 40
    s_mul_i32 s30, s3, 10
    s_add_u32 s29, s29, s30
    s_mul_i32 s29, s29, 3840
    s_min_u32 s30, s28, 14
    s_lshl_b32 s30, s30, 8
    s_add_u32 s29, s29, s30
    buffer_load_dword v210, v25, s[40:43], s29 offen
    s_add_u32 s29, s29, 3840
    buffer_load_dword v211, v25, s[40:43], s29 offen
    s_add_u32 s29, s29, 3840
    buffer_load_dword v212, v25, s[40:43], s29 offen
    s_add_u32 s29, s29, 3840
    buffer_load_dword v213, v25, s[40:43], s29 offen
    s_add_u32 s29, s29, 3840
    buffer_load_dword v214, v25, s[40:43], s29 offen
    s_add_u32 s29, s29, 3840
    buffer_load_dword v215, v25, s[40:43], s29 offen
    s_add_u32 s29, s29, 3840
    buffer_load_dword v216, v25, s[40:43], s29 offen
    s_add_u32 s29, s29, 3840
    buffer_load_dword v217, v25, s[40:43], s29 offen
    s_add_u32 s29, s29, 3840
    buffer_load_dword v218, v25, s[40:43], s29 offen
    s_add_u32 s29, s29, 3840
    buffer_load_dword v219, v25, s[40:43], s29 offen
    s_cmp_ge_u32 s28, 15
    s_cbranch_scc1 L_p1_idle
    s_waitcnt lgkmcnt(0)
    s_barrier
    s_cmp_ge_u32 s28, 10
    s_cbranch_scc1 L_p1_v
    ds_read_b128 v[32:35], v8 offset:0
    ds_read_b128 v[36:39], v8 offset:4096
    ds_read_b64_tr_b16 v[40:41], v16 offset:0
    ds_read_b64_tr_b16 v[42:43], v16 offset:1024
    ds_read_b64_tr_b16 v[44:45], v17 offset:0
    ds_read_b64_tr_b16 v[46:47], v17 offset:1024
    ds_read_b128 v[48:51], v9 offset:0
    ds_read_b128 v[52:55], v9 offset:4096
    ds_read_b64_tr_b16 v[56:57], v16 offset:4096
    ds_read_b64_tr_b16 v[58:59], v16 offset:5120
    ds_read_b64_tr_b16 v[60:61], v17 offset:4096
    ds_read_b64_tr_b16 v[62:63], v17 offset:5120
    s_waitcnt lgkmcnt(6)
    v_mfma_f32_32x32x16_bf16 v[64:79], v[40:43], v[32:35], 0
    v_mfma_f32_32x32x16_bf16 v[80:95], v[44:47], v[32:35], 0
    v_mfma_f32_32x32x16_bf16 v[96:111], v[40:43], v[36:39], 0
    v_mfma_f32_32x32x16_bf16 v[112:127], v[44:47], v[36:39], 0
    ds_read_b128 v[32:35], v10 offset:0
    ds_read_b128 v[36:39], v10 offset:4096
    ds_read_b64_tr_b16 v[40:41], v16 offset:8192
    ds_read_b64_tr_b16 v[42:43], v16 offset:9216
    ds_read_b64_tr_b16 v[44:45], v17 offset:8192
    ds_read_b64_tr_b16 v[46:47], v17 offset:9216
    s_waitcnt lgkmcnt(6)
    v_mfma_f32_32x32x16_bf16 v[64:79], v[56:59], v[48:51], v[64:79]
    v_mfma_f32_32x32x16_bf16 v[80:95], v[60:63], v[48:51], v[80:95]
    v_mfma_f32_32x32x16_bf16 v[96:111], v[56:59], v[52:55], v[96:111]
    v_mfma_f32_32x32x16_bf16 v[112:127], v[60:63], v[52:55], v[112:127]
    ds_read_b128 v[48:51], v11 offset:0
    ds_read_b128 v[52:55], v11 offset:4096
    ds_read_b64_tr_b16 v[56:57], v16 offset:12288
    ds_read_b64_tr_b16 v[58:59], v16 offset:13312
    ds_read_b64_tr_b16 v[60:61], v17 offset:12288
    ds_read_b64_tr_b16 v[62:63], v17 offset:13312
    s_waitcnt lgkmcnt(6)
    v_mfma_f32_32x32x16_bf16 v[64:79], v[40:43], v[32:35], v[64:79]
    v_mfma_f32_32x32x16_bf16 v[80:95], v[44:47], v[32:35], v[80:95]
    v_mfma_f32_32x32x16_bf16 v[96:111], v[40:43], v[36:39], v[96:111]
    v_mfma_f32_32x32x16_bf16 v[112:127], v[44:47], v[36:39], v[112:127]
    s_barrier
    ds_read_b128 v[32:35], v8 offset:32768
    ds_read_b128 v[36:39], v8 offset:36864
    ds_read_b64_tr_b16 v[40:41], v16 offset:32768
    ds_read_b64_tr_b16 v[42:43], v16 offset:33792
    ds_read_b64_tr_b16 v[44:45], v17 offset:32768
    ds_read_b64_tr_b16 v[46:47], v17 offset:33792
    s_waitcnt lgkmcnt(6)
    v_mfma_f32_32x32x16_bf16 v[64:79], v[56:59], v[48:51], v[64:79]
    v_mfma_f32_32x32x16_bf16 v[80:95], v[60:63], v[48:51], v[80:95]
    v_mfma_f32_32x32x16_bf16 v[96:111], v[56:59], v[52:55], v[96:111]
    v_mfma_f32_32x32x16_bf16 v[112:127], v[60:63], v[52:55], v[112:127]
    ds_read_b128 v[48:51], v9 offset:32768
    ds_read_b128 v[52:55], v9 offset:36864
    ds_read_b64_tr_b16 v[56:57], v16 offset:36864
    ds_read_b64_tr_b16 v[58:59], v16 offset:37888
    ds_read_b64_tr_b16 v[60:61], v17 offset:36864
    ds_read_b64_tr_b16 v[62:63], v17 offset:37888
    s_waitcnt lgkmcnt(6)
    v_mfma_f32_32x32x16_bf16 v[64:79], v[40:43], v[32:35], v[64:79]
    v_mfma_f32_32x32x16_bf16 v[80:95], v[44:47], v[32:35], v[80:95]
    v_mfma_f32_32x32x16_bf16 v[96:111], v[40:43], v[36:39], v[96:111]
    v_mfma_f32_32x32x16_bf16 v[112:127], v[44:47], v[36:39], v[112:127]
    ds_read_b128 v[32:35], v10 offset:32768
    ds_read_b128 v[36:39], v10 offset:36864
    ds_read_b64_tr_b16 v[40:41], v16 offset:40960
    ds_read_b64_tr_b16 v[42:43], v16 offset:41984
    ds_read_b64_tr_b16 v[44:45], v17 offset:40960
    ds_read_b64_tr_b16 v[46:47], v17 offset:41984
    s_waitcnt lgkmcnt(6)
    v_mfma_f32_32x32x16_bf16 v[64:79], v[56:59], v[48:51], v[64:79]
    v_mfma_f32_32x32x16_bf16 v[80:95], v[60:63], v[48:51], v[80:95]
    v_mfma_f32_32x32x16_bf16 v[96:111], v[56:59], v[52:55], v[96:111]
    v_mfma_f32_32x32x16_bf16 v[112:127], v[60:63], v[52:55], v[112:127]
    v_mov_b32 v220, 0
    v_mov_b32 v221, 0
    v_mov_b32 v222, 0
    v_mov_b32 v223, 0
    s_mov_b32 s30, 1065369472
    s_waitcnt vmcnt(10)
    v_dot2_f32_bf16 v220, v190, s30, v220
    v_dot2_f32_bf16 v221, v190, v190, v221
    v_dot2_f32_bf16 v222, v190, v200, v222
    v_dot2_f32_bf16 v223, v200, s30, v223
    v_dot2_f32_bf16 v220, v191, s30, v220
    v_dot2_f32_bf16 v221, v191, v191, v221
    v_dot2_f32_bf16 v222, v191, v201, v222
    v_dot2_f32_bf16 v223, v201, s30, v223
    v_dot2_f32_bf16 v220, v192, s30, v220
    v_dot2_f32_bf16 v221, v192, v192, v221
    v_dot2_f32_bf16 v222, v192, v202, v222
    v_dot2_f32_bf16 v223, v202, s30, v223
    v_dot2_f32_bf16 v220, v193, s30, v220
    v_dot2_f32_bf16 v221, v193, v193, v221
    v_dot2_f32_bf16 v222, v193, v203, v222
    v_dot2_f32_bf16 v223, v203, s30, v223
    v_dot2_f32_bf16 v220, v194, s30, v220
    v_dot2_f32_bf16 v221, v194, v194, v221
    v_dot2_f32_bf16 v222, v194, v204, v222
    v_dot2_f32_bf16 v223, v204, s30, v223
    v_dot2_f32_bf16 v220, v195, s30, v220
    v_dot2_f32_bf16 v221, v195, v195, v221
    v_dot2_f32_bf16 v222, v195, v205, v222
    v_dot2_f32_bf16 v223, v205, s30, v223
    v_dot2_f32_bf16 v220, v196, s30, v220
    v_dot2_f32_bf16 v221, v196, v196, v221
    v_dot2_f32_bf16 v222, v196, v206, v222
    v_dot2_f32_bf16 v223, v206, s30, v223
    v_dot2_f32_bf16 v220, v197, s30, v220
    v_dot2_f32_bf16 v221, v197, v197, v221
    v_dot2_f32_bf16 v222, v197, v207, v222
    v_dot2_f32_bf16 v223, v207, s30, v223
    v_dot2_f32_bf16 v220, v198, s30, v220
    v_dot2_f32_bf16 v221, v198, v198, v221
    v_dot2_f32_bf16 v222, v198, v208, v222
    v_dot2_f32_bf16 v223, v208, s30, v223
    v_dot2_f32_bf16 v220, v199, s30, v220
    v_dot2_f32_bf16 v221, v199, v199, v221
    v_dot2_f32_bf16 v222, v199, v209, v222
    v_dot2_f32_bf16 v223, v209, s30, v223
    s_nop 3
    v_add_f32_dpp v220, v220, v220 row_shr:1 row_mask:0xf bank_mask:0xf
    v_add_f32_dpp v221, v221, v221 row_shr:1 row_mask:0xf bank_mask:0xf
    v_add_f32_dpp v222, v222, v222 row_shr:1 row_mask:0xf bank_mask:0xf
    v_add_f32_dpp v223, v223, v223 row_shr:1 row_mask:0xf bank_mask:0xf
    v_add_f32_dpp v220, v220, v220 row_shr:2 row_mask:0xf bank_mask:0xf
    v_add_f32_dpp v221, v221, v221 row_shr:2 row_mask:0xf bank_mask:0xf
    v_add_f32_dpp v222, v222, v222 row_shr:2 row_mask:0xf bank_mask:0xf
    v_add_f32_dpp v223, v223, v223 row_shr:2 row_mask:0xf bank_mask:0xf
    v_add_f32_dpp v220, v220, v220 row_shr:4 row_mask:0xf bank_mask:0xf
    v_add_f32_dpp v221, v221, v221 row_shr:4 row_mask:0xf bank_mask:0xf
    v_add_f32_dpp v222, v222, v222 row_shr:4 row_mask:0xf bank_mask:0xf
    v_add_f32_dpp v223, v223, v223 row_shr:4 row_mask:0xf bank_mask:0xf
    v_add_f32_dpp v220, v220, v220 row_shr:8 row_mask:0xf bank_mask:0xf
    v_add_f32_dpp v221, v221, v221 row_shr:8 row_mask:0xf bank_mask:0xf
    v_add_f32_dpp v222, v222, v222 row_shr:8 row_mask:0xf bank_mask:0xf
    v_add_f32_dpp v223, v223, v223 row_shr:8 row_mask:0xf bank_mask:0xf
    v_add_f32_dpp v220, v220, v220 row_bcast:15 row_mask:0xa bank_mask:0xf
    v_add_f32_dpp v221, v221, v221 row_bcast:15 row_mask:0xa bank_mask:0xf
    v_add_f32_dpp v222, v222, v222 row_bcast:15 row_mask:0xa bank_mask:0xf
    v_add_f32_dpp v223, v223, v223 row_bcast:15 row_mask:0xa bank_mask:0xf
    s_mov_b32 s30, 0x3acccccd
    v_mul_f32 v160, s30, v220
    v_mul_f32 v221, s30, v221
    v_fma_f32 v221, -v160, v160, v221
    v_max_f32 v221, 0, v221
    v_add_f32 v221, 0x3727c5ac, v221
    v_rsq_f32 v161, v221
    v_fma_f32 v222, -v160, v223, v222
    s_nop 0
    v_mul_f32 v162, v222, v161
    v_ashrrev_i32 v220, 31, v162
    v_or_b32 v220, 0x80000000, v220
    v_xor_b32 v220, v220, v162
    v_and_b32 v220, 0xfffff800, v220
    v_or_b32 v163, v220, v164
    ds_read_b128 v[48:51], v11 offset:32768
    ds_read_b128 v[52:55], v11 offset:36864
    ds_read_b64_tr_b16 v[56:57], v16 offset:45056
    ds_read_b64_tr_b16 v[58:59], v16 offset:46080
    ds_read_b64_tr_b16 v[60:61], v17 offset:45056
    ds_read_b64_tr_b16 v[62:63], v17 offset:46080
    s_waitcnt lgkmcnt(6)
    v_mfma_f32_32x32x16_bf16 v[64:79], v[40:43], v[32:35], v[64:79]
    v_mfma_f32_32x32x16_bf16 v[80:95], v[44:47], v[32:35], v[80:95]
    v_mfma_f32_32x32x16_bf16 v[96:111], v[40:43], v[36:39], v[96:111]
    v_mfma_f32_32x32x16_bf16 v[112:127], v[44:47], v[36:39], v[112:127]
    v_mov_b32 v220, 0
    v_mov_b32 v221, 0
    s_mov_b32 s30, 0x00003f80
    s_mov_b32 s31, 0x3f800000
    s_waitcnt vmcnt(0)
    v_dot2_f32_bf16 v220, v210, s30, v220
    v_dot2_f32_bf16 v221, v210, s31, v221
    v_dot2_f32_bf16 v220, v211, s30, v220
    v_dot2_f32_bf16 v221, v211, s31, v221
    v_dot2_f32_bf16 v220, v212, s30, v220
    v_dot2_f32_bf16 v221, v212, s31, v221
    v_dot2_f32_bf16 v220, v213, s30, v220
    v_dot2_f32_bf16 v221, v213, s31, v221
    v_dot2_f32_bf16 v220, v214, s30, v220
    v_dot2_f32_bf16 v221, v214, s31, v221
    v_dot2_f32_bf16 v220, v215, s30, v220
    v_dot2_f32_bf16 v221, v215, s31, v221
    v_dot2_f32_bf16 v220, v216, s30, v220
    v_dot2_f32_bf16 v221, v216, s31, v221
    v_dot2_f32_bf16 v220, v217, s30, v220
    v_dot2_f32_bf16 v221, v217, s31, v221
    v_dot2_f32_bf16 v220, v218, s30, v220
    v_dot2_f32_bf16 v221, v218, s31, v221
    v_dot2_f32_bf16 v220, v219, s30, v220
    v_dot2_f32_bf16 v221, v219, s31, v221
    s_lshl_b32 s29, s3, 9
    s_add_u32 s29, s29, 157696
    v_lshlrev_b32 v222, 3, v255
    v_add_u32 v222, s29, v222
    s_nop 1
    ds_write_b64 v222, v[220:221]
    s_waitcnt lgkmcnt(0)
    s_barrier
    ds_read_b128 v[32:35], v12 offset:0
    ds_read_b128 v[36:39], v12 offset:4096
    ds_read_b64_tr_b16 v[40:41], v18 offset:0
    ds_read_b64_tr_b16 v[42:43], v18 offset:1024
    ds_read_b64_tr_b16 v[44:45], v19 offset:0
    ds_read_b64_tr_b16 v[46:47], v19 offset:1024
    s_waitcnt lgkmcnt(6)
    v_mfma_f32_32x32x16_bf16 v[64:79], v[56:59], v[48:51], v[64:79]
    v_mfma_f32_32x32x16_bf16 v[80:95], v[60:63], v[48:51], v[80:95]
    v_mfma_f32_32x32x16_bf16 v[96:111], v[56:59], v[52:55], v[96:111]
    v_mfma_f32_32x32x16_bf16 v[112:127], v[60:63], v[52:55], v[112:127]
    ds_read_b128 v[48:51], v13 offset:0
    ds_read_b128 v[52:55], v13 offset:4096
    ds_read_b64_tr_b16 v[56:57], v18 offset:4096
    ds_read_b64_tr_b16 v[58:59], v18 offset:5120
    ds_read_b64_tr_b16 v[60:61], v19 offset:4096
    ds_read_b64_tr_b16 v[62:63], v19 offset:5120
    s_waitcnt lgkmcnt(6)
    v_mfma_f32_32x32x16_bf16 v[64:79], v[40:43], v[32:35], v[64:79]
    v_mfma_f32_32x32x16_bf16 v[80:95], v[44:47], v[32:35], v[80:95]
    v_mfma_f32_32x32x16_bf16 v[96:111], v[40:43], v[36:39], v[96:111]
    v_mfma_f32_32x32x16_bf16 v[112:127], v[44:47], v[36:39], v[112:127]
    v_mov_b32 v170, 0
    buffer_load_dword v171, v170, s[52:55], 0 offen sc1
    ds_read_b128 v[32:35], v14 offset:0
    ds_read_b128 v[36:39], v14 offset:4096
    ds_read_b64_tr_b16 v[40:41], v18 offset:8192
    ds_read_b64_tr_b16 v[42:43], v18 offset:9216
    ds_read_b64_tr_b16 v[44:45], v19 offset:8192
    ds_read_b64_tr_b16 v[46:47], v19 offset:9216
    s_waitcnt lgkmcnt(6)
    v_mfma_f32_32x32x16_bf16 v[64:79], v[56:59], v[48:51], v[64:79]
    v_mfma_f32_32x32x16_bf16 v[80:95], v[60:63], v[48:51], v[80:95]
    v_mfma_f32_32x32x16_bf16 v[96:111], v[56:59], v[52:55], v[96:111]
    v_mfma_f32_32x32x16_bf16 v[112:127], v[60:63], v[52:55], v[112:127]
    ds_read_b128 v[48:51], v15 offset:0
    ds_read_b128 v[52:55], v15 offset:4096
    ds_read_b64_tr_b16 v[56:57], v18 offset:12288
    ds_read_b64_tr_b16 v[58:59], v18 offset:13312
    ds_read_b64_tr_b16 v[60:61], v19 offset:12288
    ds_read_b64_tr_b16 v[62:63], v19 offset:13312
    s_waitcnt lgkmcnt(6)
    v_mfma_f32_32x32x16_bf16 v[64:79], v[40:43], v[32:35], v[64:79]
    v_mfma_f32_32x32x16_bf16 v[80:95], v[44:47], v[32:35], v[80:95]
    v_mfma_f32_32x32x16_bf16 v[96:111], v[40:43], v[36:39], v[96:111]
    v_mfma_f32_32x32x16_bf16 v[112:127], v[44:47], v[36:39], v[112:127]
    s_barrier
    ds_read_b128 v[32:35], v12 offset:32768
    ds_read_b128 v[36:39], v12 offset:36864
    ds_read_b64_tr_b16 v[40:41], v18 offset:32768
    ds_read_b64_tr_b16 v[42:43], v18 offset:33792
    ds_read_b64_tr_b16 v[44:45], v19 offset:32768
    ds_read_b64_tr_b16 v[46:47], v19 offset:33792
    s_waitcnt lgkmcnt(6)
    v_mfma_f32_32x32x16_bf16 v[64:79], v[56:59], v[48:51], v[64:79]
    v_mfma_f32_32x32x16_bf16 v[80:95], v[60:63], v[48:51], v[80:95]
    v_mfma_f32_32x32x16_bf16 v[96:111], v[56:59], v[52:55], v[96:111]
    v_mfma_f32_32x32x16_bf16 v[112:127], v[60:63], v[52:55], v[112:127]
    ds_read_b128 v[48:51], v13 offset:32768
    ds_read_b128 v[52:55], v13 offset:36864
    ds_read_b64_tr_b16 v[56:57], v18 offset:36864
    ds_read_b64_tr_b16 v[58:59], v18 offset:37888
    ds_read_b64_tr_b16 v[60:61], v19 offset:36864
    ds_read_b64_tr_b16 v[62:63], v19 offset:37888
    s_waitcnt lgkmcnt(6)
    v_mfma_f32_32x32x16_bf16 v[64:79], v[40:43], v[32:35], v[64:79]
    v_mfma_f32_32x32x16_bf16 v[80:95], v[44:47], v[32:35], v[80:95]
    v_mfma_f32_32x32x16_bf16 v[96:111], v[40:43], v[36:39], v[96:111]
    v_mfma_f32_32x32x16_bf16 v[112:127], v[44:47], v[36:39], v[112:127]
    ds_read_b128 v[32:35], v14 offset:32768
    ds_read_b128 v[36:39], v14 offset:36864
    ds_read_b64_tr_b16 v[40:41], v18 offset:40960
    ds_read_b64_tr_b16 v[42:43], v18 offset:41984
    ds_read_b64_tr_b16 v[44:45], v19 offset:40960
    ds_read_b64_tr_b16 v[46:47], v19 offset:41984
    s_waitcnt lgkmcnt(6)
    v_mfma_f32_32x32x16_bf16 v[64:79], v[56:59], v[48:51], v[64:79]
    v_mfma_f32_32x32x16_bf16 v[80:95], v[60:63], v[48:51], v[80:95]
    v_mfma_f32_32x32x16_bf16 v[96:111], v[56:59], v[52:55], v[96:111]
    v_mfma_f32_32x32x16_bf16 v[112:127], v[60:63], v[52:55], v[112:127]
    ds_read_b128 v[48:51], v15 offset:32768
    ds_read_b128 v[52:55], v15 offset:36864
    ds_read_b64_tr_b16 v[56:57], v18 offset:45056
    ds_read_b64_tr_b16 v[58:59], v18 offset:46080
    ds_read_b64_tr_b16 v[60:61], v19 offset:45056
    ds_read_b64_tr_b16 v[62:63], v19 offset:46080
    s_waitcnt lgkmcnt(6)
    v_mfma_f32_32x32x16_bf16 v[64:79], v[40:43], v[32:35], v[64:79]
    v_mfma_f32_32x32x16_bf16 v[80:95], v[44:47], v[32:35], v[80:95]
    v_mfma_f32_32x32x16_bf16 v[96:111], v[40:43], v[36:39], v[96:111]
    v_mfma_f32_32x32x16_bf16 v[112:127], v[44:47], v[36:39], v[112:127]
    s_barrier
    ds_read_b128 v[32:35], v8 offset:0
    ds_read_b128 v[36:39], v8 offset:4096
    ds_read_b64_tr_b16 v[40:41], v16 offset:0
    ds_read_b64_tr_b16 v[42:43], v16 offset:1024
    ds_read_b64_tr_b16 v[44:45], v17 offset:0
    ds_read_b64_tr_b16 v[46:47], v17 offset:1024
    s_waitcnt lgkmcnt(6)
    v_mfma_f32_32x32x16_bf16 v[64:79], v[56:59], v[48:51], v[64:79]
    v_mfma_f32_32x32x16_bf16 v[80:95], v[60:63], v[48:51], v[80:95]
    v_mfma_f32_32x32x16_bf16 v[96:111], v[56:59], v[52:55], v[96:111]
    v_mfma_f32_32x32x16_bf16 v[112:127], v[60:63], v[52:55], v[112:127]
    ds_read_b128 v[48:51], v9 offset:0
    ds_read_b128 v[52:55], v9 offset:4096
    ds_read_b64_tr_b16 v[56:57], v16 offset:4096
    ds_read_b64_tr_b16 v[58:59], v16 offset:5120
    ds_read_b64_tr_b16 v[60:61], v17 offset:4096
    ds_read_b64_tr_b16 v[62:63], v17 offset:5120
    s_waitcnt lgkmcnt(6)
    v_mfma_f32_32x32x16_bf16 v[64:79], v[40:43], v[32:35], v[64:79]
    v_mfma_f32_32x32x16_bf16 v[80:95], v[44:47], v[32:35], v[80:95]
    v_mfma_f32_32x32x16_bf16 v[96:111], v[40:43], v[36:39], v[96:111]
    v_mfma_f32_32x32x16_bf16 v[112:127], v[44:47], v[36:39], v[112:127]
    s_waitcnt vmcnt(0)
    v_readfirstlane_b32 s26, v171
    s_cmp_lg_u32 s26, 0
    s_cbranch_scc1 L_p1a_nonce_ok
    v_mov_b32 v170, 0
    s_mov_b32 s67, 200000
L_p1a_nonce:
    buffer_load_dword v171, v170, s[52:55], 0 offen sc1
    s_waitcnt vmcnt(0)
    v_readfirstlane_b32 s26, v171
    s_cmp_lg_u32 s26, 0
    s_cbranch_scc1 L_p1a_nonce_ok
    s_sleep 2
    s_sub_u32 s67, s67, 1
    s_cmp_lg_u32 s67, 0
    s_cbranch_scc1 L_p1a_nonce
L_p1a_nonce_ok:
    v_mov_b32 v170, 163328
    v_mov_b32 v171, s26
    ds_write_b32 v170, v171
    s_add_u32 s32, s24, 0xa04600
    s_addc_u32 s33, s25, 0
    s_mov_b32 s34, 0x8000
    s_mov_b32 s35, 0x00020000
    s_add_u32 s36, s24, 0xa50800
    s_addc_u32 s37, s25, 0
    s_mov_b32 s38, 0x8000
    s_mov_b32 s39, 0x00020000
    v_mov_b32 v172, v160
    v_mov_b32 v173, s26
    v_mov_b32 v174, v161
    v_mov_b32 v175, s26
    v_lshlrev_b32 v176, 3, v164
    v_lshlrev_b32 v177, 2, v164
    v_lshlrev_b32 v178, 4, v164
    s_mov_b32 s29, 16384
    s_mov_b32 s30, 24576
    v_and_b32 v179, 31, v255
    v_cmp_eq_u32 vcc, 31, v179
    s_and_saveexec_b64 s[56:57], vcc
    buffer_store_dwordx4 v[172:175], v178, s[36:39], 0 offen sc1
    buffer_store_dwordx2 v[160:161], v176, s[32:35], 0 offen sc1
    buffer_store_dword v162, v177, s[32:35], s29 offen sc1
    buffer_store_dword v163, v177, s[32:35], s30 offen sc1
    s_mov_b64 exec, s[56:57]
    s_cmp_lg_u32 s3, 0
    s_cbranch_scc1 L_p1a_nocs
    v_lshlrev_b32 v192, 3, v255
    v_add_u32 v193, 157696, v192
    ds_read_b64 v[184:185], v193
    ds_read_b64 v[186:187], v193 offset:512
    ds_read_b64 v[188:189], v193 offset:1024
    ds_read_b64 v[190:191], v193 offset:1536
    s_add_u32 s32, s24, 0xa0c600
    s_addc_u32 s33, s25, 0
    s_mov_b32 s34, 0x40000
    s_mov_b32 s35, 0x00020000
    s_lshl_b32 s29, s28, 4
    s_add_u32 s29, s29, s27
    s_lshl_b32 s29, s29, 10
    v_lshlrev_b32 v192, 4, v255
    s_waitcnt lgkmcnt(0)
    v_add_f32 v184, v184, v186
    v_add_f32 v185, v185, v187
    v_add_f32 v188, v188, v190
    v_add_f32 v189, v189, v191
    v_add_f32 v184, v184, v188
    v_add_f32 v186, v185, v189
    v_mov_b32 v185, s26
    v_mov_b32 v187, s26
    buffer_store_dwordx4 v[184:187], v192, s[32:35], s29 offen sc1
L_p1a_nocs:
    s_waitcnt lgkmcnt(0)
    ds_read_b128 v[32:35], v10 offset:0
    ds_read_b128 v[36:39], v10 offset:4096
    ds_read_b64_tr_b16 v[40:41], v16 offset:8192
    ds_read_b64_tr_b16 v[42:43], v16 offset:9216
    ds_read_b64_tr_b16 v[44:45], v17 offset:8192
    ds_read_b64_tr_b16 v[46:47], v17 offset:9216
    s_waitcnt lgkmcnt(6)
    v_mfma_f32_32x32x16_bf16 v[64:79], v[56:59], v[48:51], v[64:79]
    v_mfma_f32_32x32x16_bf16 v[80:95], v[60:63], v[48:51], v[80:95]
    v_mfma_f32_32x32x16_bf16 v[96:111], v[56:59], v[52:55], v[96:111]
    v_mfma_f32_32x32x16_bf16 v[112:127], v[60:63], v[52:55], v[112:127]
    ds_read_b128 v[48:51], v11 offset:0
    ds_read_b128 v[52:55], v11 offset:4096
    ds_read_b64_tr_b16 v[56:57], v16 offset:12288
    ds_read_b64_tr_b16 v[58:59], v16 offset:13312
    ds_read_b64_tr_b16 v[60:61], v17 offset:12288
    ds_read_b64_tr_b16 v[62:63], v17 offset:13312
    s_waitcnt lgkmcnt(6)
    v_mfma_f32_32x32x16_bf16 v[64:79], v[40:43], v[32:35], v[64:79]
    v_mfma_f32_32x32x16_bf16 v[80:95], v[44:47], v[32:35], v[80:95]
    v_mfma_f32_32x32x16_bf16 v[96:111], v[40:43], v[36:39], v[96:111]
    v_mfma_f32_32x32x16_bf16 v[112:127], v[44:47], v[36:39], v[112:127]
    s_barrier
    ds_read_b128 v[32:35], v8 offset:32768
    ds_read_b128 v[36:39], v8 offset:36864
    ds_read_b64_tr_b16 v[40:41], v16 offset:32768
    ds_read_b64_tr_b16 v[42:43], v16 offset:33792
    ds_read_b64_tr_b16 v[44:45], v17 offset:32768
    ds_read_b64_tr_b16 v[46:47], v17 offset:33792
    s_waitcnt lgkmcnt(6)
    v_mfma_f32_32x32x16_bf16 v[64:79], v[56:59], v[48:51], v[64:79]
    v_mfma_f32_32x32x16_bf16 v[80:95], v[60:63], v[48:51], v[80:95]
    v_mfma_f32_32x32x16_bf16 v[96:111], v[56:59], v[52:55], v[96:111]
    v_mfma_f32_32x32x16_bf16 v[112:127], v[60:63], v[52:55], v[112:127]
    ds_read_b128 v[48:51], v9 offset:32768
    ds_read_b128 v[52:55], v9 offset:36864
    ds_read_b64_tr_b16 v[56:57], v16 offset:36864
    ds_read_b64_tr_b16 v[58:59], v16 offset:37888
    ds_read_b64_tr_b16 v[60:61], v17 offset:36864
    ds_read_b64_tr_b16 v[62:63], v17 offset:37888
    s_waitcnt lgkmcnt(6)
    v_mfma_f32_32x32x16_bf16 v[64:79], v[40:43], v[32:35], v[64:79]
    v_mfma_f32_32x32x16_bf16 v[80:95], v[44:47], v[32:35], v[80:95]
    v_mfma_f32_32x32x16_bf16 v[96:111], v[40:43], v[36:39], v[96:111]
    v_mfma_f32_32x32x16_bf16 v[112:127], v[44:47], v[36:39], v[112:127]
    ds_read_b128 v[32:35], v10 offset:32768
    ds_read_b128 v[36:39], v10 offset:36864
    ds_read_b64_tr_b16 v[40:41], v16 offset:40960
    ds_read_b64_tr_b16 v[42:43], v16 offset:41984
    ds_read_b64_tr_b16 v[44:45], v17 offset:40960
    ds_read_b64_tr_b16 v[46:47], v17 offset:41984
    s_waitcnt lgkmcnt(6)
    v_mfma_f32_32x32x16_bf16 v[64:79], v[56:59], v[48:51], v[64:79]
    v_mfma_f32_32x32x16_bf16 v[80:95], v[60:63], v[48:51], v[80:95]
    v_mfma_f32_32x32x16_bf16 v[96:111], v[56:59], v[52:55], v[96:111]
    v_mfma_f32_32x32x16_bf16 v[112:127], v[60:63], v[52:55], v[112:127]
    ds_read_b128 v[48:51], v11 offset:32768
    ds_read_b128 v[52:55], v11 offset:36864
    ds_read_b64_tr_b16 v[56:57], v16 offset:45056
    ds_read_b64_tr_b16 v[58:59], v16 offset:46080
    ds_read_b64_tr_b16 v[60:61], v17 offset:45056
    ds_read_b64_tr_b16 v[62:63], v17 offset:46080
    s_waitcnt lgkmcnt(6)
    v_mfma_f32_32x32x16_bf16 v[64:79], v[40:43], v[32:35], v[64:79]
    v_mfma_f32_32x32x16_bf16 v[80:95], v[44:47], v[32:35], v[80:95]
    v_mfma_f32_32x32x16_bf16 v[96:111], v[40:43], v[36:39], v[96:111]
    v_mfma_f32_32x32x16_bf16 v[112:127], v[44:47], v[36:39], v[112:127]
    s_barrier
    ds_read_b128 v[32:35], v12 offset:0
    ds_read_b128 v[36:39], v12 offset:4096
    ds_read_b64_tr_b16 v[40:41], v18 offset:0
    ds_read_b64_tr_b16 v[42:43], v18 offset:1024
    ds_read_b64_tr_b16 v[44:45], v19 offset:0
    ds_read_b64_tr_b16 v[46:47], v19 offset:1024
    s_waitcnt lgkmcnt(6)
    v_mfma_f32_32x32x16_bf16 v[64:79], v[56:59], v[48:51], v[64:79]
    v_mfma_f32_32x32x16_bf16 v[80:95], v[60:63], v[48:51], v[80:95]
    v_mfma_f32_32x32x16_bf16 v[96:111], v[56:59], v[52:55], v[96:111]
    v_mfma_f32_32x32x16_bf16 v[112:127], v[60:63], v[52:55], v[112:127]
    s_cmp_ge_u32 s28, 5
    s_cselect_b32 s29, 2621696, 0
    s_cselect_b32 s56, 1.0, 0x3ea52b5c
    s_cselect_b32 s30, 5, 0
    s_sub_u32 s57, s28, s30
    s_add_u32 s29, s29, 256
    s_add_u32 s32, s24, s29
    s_addc_u32 s33, s25, 0
    s_mov_b32 s34, 0x280000
    s_mov_b32 s35, 0x00020000
    v_and_b32 v3, 31, v255
    v_lshrrev_b32 v4, 5, v255
    s_and_b32 s29, s3, 1
    s_lshl_b32 s29, s29, 6
    v_add_u32 v5, s29, v3
    v_lshlrev_b32 v201, 2, v5
    v_add_u32 v201, 162304, v201
    s_lshr_b32 s58, s3, 1
    s_lshl_b32 s29, s58, 8
    v_lshlrev_b32 v202, 5, v4
    v_add_u32 v202, s29, v202
    v_add_u32 v202, 161792, v202
    s_lshl_b32 s29, s27, 7
    v_add_u32 v5, s29, v5
    v_lshlrev_b32 v5, 4, v5
    v_lshl_add_u32 v200, v4, 15, v5
    s_lshl_b32 s59, s57, 4
    s_lshl_b32 s29, s58, 3
    s_add_u32 s59, s59, s29
    s_lshl_b32 s59, s59, 15
    ds_read_b128 v[48:51], v13 offset:0
    ds_read_b128 v[52:55], v13 offset:4096
    ds_read_b64_tr_b16 v[56:57], v18 offset:4096
    ds_read_b64_tr_b16 v[58:59], v18 offset:5120
    ds_read_b64_tr_b16 v[60:61], v19 offset:4096
    ds_read_b64_tr_b16 v[62:63], v19 offset:5120
    s_waitcnt lgkmcnt(6)
    v_mfma_f32_32x32x16_bf16 v[64:79], v[40:43], v[32:35], v[64:79]
    v_mfma_f32_32x32x16_bf16 v[80:95], v[44:47], v[32:35], v[80:95]
    v_mfma_f32_32x32x16_bf16 v[96:111], v[40:43], v[36:39], v[96:111]
    v_mfma_f32_32x32x16_bf16 v[112:127], v[44:47], v[36:39], v[112:127]
    ds_read_b128 v[32:35], v14 offset:0
    ds_read_b128 v[36:39], v14 offset:4096
    ds_read_b64_tr_b16 v[40:41], v18 offset:8192
    ds_read_b64_tr_b16 v[42:43], v18 offset:9216
    ds_read_b64_tr_b16 v[44:45], v19 offset:8192
    ds_read_b64_tr_b16 v[46:47], v19 offset:9216
    s_waitcnt lgkmcnt(6)
    v_mfma_f32_32x32x16_bf16 v[64:79], v[56:59], v[48:51], v[64:79]
    v_mfma_f32_32x32x16_bf16 v[80:95], v[60:63], v[48:51], v[80:95]
    v_mfma_f32_32x32x16_bf16 v[96:111], v[56:59], v[52:55], v[96:111]
    v_mfma_f32_32x32x16_bf16 v[112:127], v[60:63], v[52:55], v[112:127]
    ds_read_b128 v[48:51], v15 offset:0
    ds_read_b128 v[52:55], v15 offset:4096
    ds_read_b64_tr_b16 v[56:57], v18 offset:12288
    ds_read_b64_tr_b16 v[58:59], v18 offset:13312
    ds_read_b64_tr_b16 v[60:61], v19 offset:12288
    ds_read_b64_tr_b16 v[62:63], v19 offset:13312
    s_waitcnt lgkmcnt(6)
    v_mfma_f32_32x32x16_bf16 v[64:79], v[40:43], v[32:35], v[64:79]
    v_mfma_f32_32x32x16_bf16 v[80:95], v[44:47], v[32:35], v[80:95]
    v_mfma_f32_32x32x16_bf16 v[96:111], v[40:43], v[36:39], v[96:111]
    v_mfma_f32_32x32x16_bf16 v[112:127], v[44:47], v[36:39], v[112:127]
    s_waitcnt vmcnt(0)
    s_barrier
    s_cmp_lg_u32 s3, 0
    s_cbranch_scc1 L_p1a_nof0
    s_add_u32 s52, s24, 0xa58800
    s_addc_u32 s53, s25, 0
    s_mov_b32 s54, 0x8000
    s_mov_b32 s55, 0x00020000
    s_lshl_b32 s29, s2, 7
    v_mov_b32 v28, s29
    v_mov_b32 v29, s26
    s_mov_b64 s[30:31], exec
    s_mov_b64 exec, 1
    buffer_store_dword v29, v28, s[52:55], 0 offen sc1
    s_mov_b64 exec, s[30:31]
L_p1a_nof0:
    ds_read_b128 v[32:35], v12 offset:32768
    ds_read_b128 v[36:39], v12 offset:36864
    ds_read_b64_tr_b16 v[40:41], v18 offset:32768
    ds_read_b64_tr_b16 v[42:43], v18 offset:33792
    ds_read_b64_tr_b16 v[44:45], v19 offset:32768
    ds_read_b64_tr_b16 v[46:47], v19 offset:33792
    s_waitcnt lgkmcnt(6)
    v_mfma_f32_32x32x16_bf16 v[64:79], v[56:59], v[48:51], v[64:79]
    v_mfma_f32_32x32x16_bf16 v[80:95], v[60:63], v[48:51], v[80:95]
    v_mfma_f32_32x32x16_bf16 v[96:111], v[56:59], v[52:55], v[96:111]
    v_mfma_f32_32x32x16_bf16 v[112:127], v[60:63], v[52:55], v[112:127]
    ds_read_b128 v[48:51], v13 offset:32768
    ds_read_b128 v[52:55], v13 offset:36864
    ds_read_b64_tr_b16 v[56:57], v18 offset:36864
    ds_read_b64_tr_b16 v[58:59], v18 offset:37888
    ds_read_b64_tr_b16 v[60:61], v19 offset:36864
    ds_read_b64_tr_b16 v[62:63], v19 offset:37888
    s_waitcnt lgkmcnt(6)
    v_mfma_f32_32x32x16_bf16 v[64:79], v[40:43], v[32:35], v[64:79]
    v_mfma_f32_32x32x16_bf16 v[80:95], v[44:47], v[32:35], v[80:95]
    v_mfma_f32_32x32x16_bf16 v[96:111], v[40:43], v[36:39], v[96:111]
    v_mfma_f32_32x32x16_bf16 v[112:127], v[44:47], v[36:39], v[112:127]
    ds_read_b128 v[32:35], v14 offset:32768
    ds_read_b128 v[36:39], v14 offset:36864
    ds_read_b64_tr_b16 v[40:41], v18 offset:40960
    ds_read_b64_tr_b16 v[42:43], v18 offset:41984
    ds_read_b64_tr_b16 v[44:45], v19 offset:40960
    ds_read_b64_tr_b16 v[46:47], v19 offset:41984
    s_waitcnt lgkmcnt(6)
    v_mfma_f32_32x32x16_bf16 v[64:79], v[56:59], v[48:51], v[64:79]
    v_mfma_f32_32x32x16_bf16 v[80:95], v[60:63], v[48:51], v[80:95]
    v_mfma_f32_32x32x16_bf16 v[96:111], v[56:59], v[52:55], v[96:111]
    v_mfma_f32_32x32x16_bf16 v[112:127], v[60:63], v[52:55], v[112:127]
    ds_read_b128 v[48:51], v15 offset:32768
    ds_read_b128 v[52:55], v15 offset:36864
    ds_read_b64_tr_b16 v[56:57], v18 offset:45056
    ds_read_b64_tr_b16 v[58:59], v18 offset:46080
    ds_read_b64_tr_b16 v[60:61], v19 offset:45056
    ds_read_b64_tr_b16 v[62:63], v19 offset:46080
    s_waitcnt lgkmcnt(6)
    v_mfma_f32_32x32x16_bf16 v[64:79], v[40:43], v[32:35], v[64:79]
    v_mfma_f32_32x32x16_bf16 v[80:95], v[44:47], v[32:35], v[80:95]
    v_mfma_f32_32x32x16_bf16 v[96:111], v[40:43], v[36:39], v[96:111]
    v_mfma_f32_32x32x16_bf16 v[112:127], v[44:47], v[36:39], v[112:127]
    s_barrier
    ds_read_b128 v[32:35], v8 offset:0
    ds_read_b128 v[36:39], v8 offset:4096
    ds_read_b64_tr_b16 v[40:41], v16 offset:0
    ds_read_b64_tr_b16 v[42:43], v16 offset:1024
    ds_read_b64_tr_b16 v[44:45], v17 offset:0
    ds_read_b64_tr_b16 v[46:47], v17 offset:1024
    s_waitcnt lgkmcnt(6)
    v_mfma_f32_32x32x16_bf16 v[64:79], v[56:59], v[48:51], v[64:79]
    v_mfma_f32_32x32x16_bf16 v[80:95], v[60:63], v[48:51], v[80:95]
    v_mfma_f32_32x32x16_bf16 v[96:111], v[56:59], v[52:55], v[96:111]
    v_mfma_f32_32x32x16_bf16 v[112:127], v[60:63], v[52:55], v[112:127]
    ds_read_b128 v[48:51], v9 offset:0
    ds_read_b128 v[52:55], v9 offset:4096
    ds_read_b64_tr_b16 v[56:57], v16 offset:4096
    ds_read_b64_tr_b16 v[58:59], v16 offset:5120
    ds_read_b64_tr_b16 v[60:61], v17 offset:4096
    ds_read_b64_tr_b16 v[62:63], v17 offset:5120
    s_waitcnt lgkmcnt(6)
    v_mfma_f32_32x32x16_bf16 v[64:79], v[40:43], v[32:35], v[64:79]
    v_mfma_f32_32x32x16_bf16 v[80:95], v[44:47], v[32:35], v[80:95]
    v_mfma_f32_32x32x16_bf16 v[96:111], v[40:43], v[36:39], v[96:111]
    v_mfma_f32_32x32x16_bf16 v[112:127], v[44:47], v[36:39], v[112:127]
    ds_read_b128 v[32:35], v10 offset:0
    ds_read_b128 v[36:39], v10 offset:4096
    ds_read_b64_tr_b16 v[40:41], v16 offset:8192
    ds_read_b64_tr_b16 v[42:43], v16 offset:9216
    ds_read_b64_tr_b16 v[44:45], v17 offset:8192
    ds_read_b64_tr_b16 v[46:47], v17 offset:9216
    s_waitcnt lgkmcnt(6)
    v_mfma_f32_32x32x16_bf16 v[64:79], v[56:59], v[48:51], v[64:79]
    v_mfma_f32_32x32x16_bf16 v[80:95], v[60:63], v[48:51], v[80:95]
    v_mfma_f32_32x32x16_bf16 v[96:111], v[56:59], v[52:55], v[96:111]
    v_mfma_f32_32x32x16_bf16 v[112:127], v[60:63], v[52:55], v[112:127]
    ds_read_b128 v[48:51], v11 offset:0
    ds_read_b128 v[52:55], v11 offset:4096
    ds_read_b64_tr_b16 v[56:57], v16 offset:12288
    ds_read_b64_tr_b16 v[58:59], v16 offset:13312
    ds_read_b64_tr_b16 v[60:61], v17 offset:12288
    ds_read_b64_tr_b16 v[62:63], v17 offset:13312
    s_waitcnt lgkmcnt(6)
    v_mfma_f32_32x32x16_bf16 v[64:79], v[40:43], v[32:35], v[64:79]
    v_mfma_f32_32x32x16_bf16 v[80:95], v[44:47], v[32:35], v[80:95]
    v_mfma_f32_32x32x16_bf16 v[96:111], v[40:43], v[36:39], v[96:111]
    v_mfma_f32_32x32x16_bf16 v[112:127], v[44:47], v[36:39], v[112:127]
    s_barrier
    ds_read_b128 v[32:35], v8 offset:32768
    ds_read_b128 v[36:39], v8 offset:36864
    ds_read_b64_tr_b16 v[40:41], v16 offset:32768
    ds_read_b64_tr_b16 v[42:43], v16 offset:33792
    ds_read_b64_tr_b16 v[44:45], v17 offset:32768
    ds_read_b64_tr_b16 v[46:47], v17 offset:33792
    s_waitcnt lgkmcnt(6)
    v_mfma_f32_32x32x16_bf16 v[64:79], v[56:59], v[48:51], v[64:79]
    v_mfma_f32_32x32x16_bf16 v[80:95], v[60:63], v[48:51], v[80:95]
    v_mfma_f32_32x32x16_bf16 v[96:111], v[56:59], v[52:55], v[96:111]
    v_mfma_f32_32x32x16_bf16 v[112:127], v[60:63], v[52:55], v[112:127]
    ds_read_b128 v[48:51], v9 offset:32768
    ds_read_b128 v[52:55], v9 offset:36864
    ds_read_b64_tr_b16 v[56:57], v16 offset:36864
    ds_read_b64_tr_b16 v[58:59], v16 offset:37888
    ds_read_b64_tr_b16 v[60:61], v17 offset:36864
    ds_read_b64_tr_b16 v[62:63], v17 offset:37888
    s_waitcnt lgkmcnt(6)
    v_mfma_f32_32x32x16_bf16 v[64:79], v[40:43], v[32:35], v[64:79]
    v_mfma_f32_32x32x16_bf16 v[80:95], v[44:47], v[32:35], v[80:95]
    v_mfma_f32_32x32x16_bf16 v[96:111], v[40:43], v[36:39], v[96:111]
    v_mfma_f32_32x32x16_bf16 v[112:127], v[44:47], v[36:39], v[112:127]
    ds_read_b128 v[32:35], v10 offset:32768
    ds_read_b128 v[36:39], v10 offset:36864
    ds_read_b64_tr_b16 v[40:41], v16 offset:40960
    ds_read_b64_tr_b16 v[42:43], v16 offset:41984
    ds_read_b64_tr_b16 v[44:45], v17 offset:40960
    ds_read_b64_tr_b16 v[46:47], v17 offset:41984
    s_waitcnt lgkmcnt(6)
    v_mfma_f32_32x32x16_bf16 v[64:79], v[56:59], v[48:51], v[64:79]
    v_mfma_f32_32x32x16_bf16 v[80:95], v[60:63], v[48:51], v[80:95]
    v_mfma_f32_32x32x16_bf16 v[96:111], v[56:59], v[52:55], v[96:111]
    v_mfma_f32_32x32x16_bf16 v[112:127], v[60:63], v[52:55], v[112:127]
    ds_read_b128 v[48:51], v11 offset:32768
    ds_read_b128 v[52:55], v11 offset:36864
    ds_read_b64_tr_b16 v[56:57], v16 offset:45056
    ds_read_b64_tr_b16 v[58:59], v16 offset:46080
    ds_read_b64_tr_b16 v[60:61], v17 offset:45056
    ds_read_b64_tr_b16 v[62:63], v17 offset:46080
    s_waitcnt lgkmcnt(6)
    v_mfma_f32_32x32x16_bf16 v[64:79], v[40:43], v[32:35], v[64:79]
    v_mfma_f32_32x32x16_bf16 v[80:95], v[44:47], v[32:35], v[80:95]
    v_mfma_f32_32x32x16_bf16 v[96:111], v[40:43], v[36:39], v[96:111]
    v_mfma_f32_32x32x16_bf16 v[112:127], v[44:47], v[36:39], v[112:127]
    s_waitcnt lgkmcnt(0)
    v_mfma_f32_32x32x16_bf16 v[64:79], v[56:59], v[48:51], v[64:79]
    v_mfma_f32_32x32x16_bf16 v[80:95], v[60:63], v[48:51], v[80:95]
    v_mfma_f32_32x32x16_bf16 v[96:111], v[56:59], v[52:55], v[96:111]
    v_mfma_f32_32x32x16_bf16 v[112:127], v[60:63], v[52:55], v[112:127]
    s_barrier
    ds_read_b32 v8, v201
    ds_read_b32 v9, v201 offset:512
    ds_read_b32 v10, v201 offset:128
    ds_read_b32 v11, v201 offset:640
    ds_read_b128 v[128:131], v202 offset:0
    ds_read_b128 v[132:135], v202 offset:16
    ds_read_b128 v[136:139], v202 offset:64
    ds_read_b128 v[140:143], v202 offset:80
    ds_read_b128 v[144:147], v202 offset:128
    ds_read_b128 v[148:151], v202 offset:144
    ds_read_b128 v[152:155], v202 offset:192
    ds_read_b128 v[156:159], v202 offset:208
    s_waitcnt lgkmcnt(8)
    v_mul_f32 v8, s56, v8
    v_mul_f32 v9, s56, v9
    v_mul_f32 v10, s56, v10
    v_mul_f32 v11, s56, v11
    s_waitcnt lgkmcnt(4)
    v_pk_mul_f32 v[48:49], v[128:129], v[8:9] op_sel:[0,1] op_sel_hi:[1,1]
    v_pk_fma_f32 v[64:65], v[64:65], v[8:9], v[48:49] op_sel_hi:[1,0,1]
    v_pk_mul_f32 v[50:51], v[130:131], v[8:9] op_sel:[0,1] op_sel_hi:[1,1]
    v_pk_fma_f32 v[66:67], v[66:67], v[8:9], v[50:51] op_sel_hi:[1,0,1]
    v_pk_mul_f32 v[48:49], v[132:133], v[8:9] op_sel:[0,1] op_sel_hi:[1,1]
    v_pk_fma_f32 v[68:69], v[68:69], v[8:9], v[48:49] op_sel_hi:[1,0,1]
    v_pk_mul_f32 v[50:51], v[134:135], v[8:9] op_sel:[0,1] op_sel_hi:[1,1]
    v_pk_fma_f32 v[70:71], v[70:71], v[8:9], v[50:51] op_sel_hi:[1,0,1]
    v_cvt_pk_bf16_f32 v32, v64, v65
    v_cvt_pk_bf16_f32 v33, v66, v67
    v_cvt_pk_bf16_f32 v34, v68, v69
    v_cvt_pk_bf16_f32 v35, v70, v71
    s_add_u32 s29, s59, 0
    buffer_store_dwordx4 v[32:35], v200, s[32:35], s29 offen sc1
    v_pk_mul_f32 v[48:49], v[136:137], v[8:9] op_sel:[0,1] op_sel_hi:[1,1]
    v_pk_fma_f32 v[72:73], v[72:73], v[8:9], v[48:49] op_sel_hi:[1,0,1]
    v_pk_mul_f32 v[50:51], v[138:139], v[8:9] op_sel:[0,1] op_sel_hi:[1,1]
    v_pk_fma_f32 v[74:75], v[74:75], v[8:9], v[50:51] op_sel_hi:[1,0,1]
    v_pk_mul_f32 v[48:49], v[140:141], v[8:9] op_sel:[0,1] op_sel_hi:[1,1]
    v_pk_fma_f32 v[76:77], v[76:77], v[8:9], v[48:49] op_sel_hi:[1,0,1]
    v_pk_mul_f32 v[50:51], v[142:143], v[8:9] op_sel:[0,1] op_sel_hi:[1,1]
    v_pk_fma_f32 v[78:79], v[78:79], v[8:9], v[50:51] op_sel_hi:[1,0,1]
    v_cvt_pk_bf16_f32 v36, v72, v73
    v_cvt_pk_bf16_f32 v37, v74, v75
    v_cvt_pk_bf16_f32 v38, v76, v77
    v_cvt_pk_bf16_f32 v39, v78, v79
    s_add_u32 s29, s59, 65536
    buffer_store_dwordx4 v[36:39], v200, s[32:35], s29 offen sc1
    s_waitcnt lgkmcnt(0)
    v_pk_mul_f32 v[48:49], v[144:145], v[8:9] op_sel:[0,1] op_sel_hi:[1,1]
    v_pk_fma_f32 v[80:81], v[80:81], v[8:9], v[48:49] op_sel_hi:[1,0,1]
    v_pk_mul_f32 v[50:51], v[146:147], v[8:9] op_sel:[0,1] op_sel_hi:[1,1]
    v_pk_fma_f32 v[82:83], v[82:83], v[8:9], v[50:51] op_sel_hi:[1,0,1]
    v_pk_mul_f32 v[48:49], v[148:149], v[8:9] op_sel:[0,1] op_sel_hi:[1,1]
    v_pk_fma_f32 v[84:85], v[84:85], v[8:9], v[48:49] op_sel_hi:[1,0,1]
    v_pk_mul_f32 v[50:51], v[150:151], v[8:9] op_sel:[0,1] op_sel_hi:[1,1]
    v_pk_fma_f32 v[86:87], v[86:87], v[8:9], v[50:51] op_sel_hi:[1,0,1]
    v_cvt_pk_bf16_f32 v40, v80, v81
    v_cvt_pk_bf16_f32 v41, v82, v83
    v_cvt_pk_bf16_f32 v42, v84, v85
    v_cvt_pk_bf16_f32 v43, v86, v87
    s_add_u32 s29, s59, 131072
    buffer_store_dwordx4 v[40:43], v200, s[32:35], s29 offen sc1
    v_pk_mul_f32 v[48:49], v[152:153], v[8:9] op_sel:[0,1] op_sel_hi:[1,1]
    v_pk_fma_f32 v[88:89], v[88:89], v[8:9], v[48:49] op_sel_hi:[1,0,1]
    v_pk_mul_f32 v[50:51], v[154:155], v[8:9] op_sel:[0,1] op_sel_hi:[1,1]
    v_pk_fma_f32 v[90:91], v[90:91], v[8:9], v[50:51] op_sel_hi:[1,0,1]
    v_pk_mul_f32 v[48:49], v[156:157], v[8:9] op_sel:[0,1] op_sel_hi:[1,1]
    v_pk_fma_f32 v[92:93], v[92:93], v[8:9], v[48:49] op_sel_hi:[1,0,1]
    v_pk_mul_f32 v[50:51], v[158:159], v[8:9] op_sel:[0,1] op_sel_hi:[1,1]
    v_pk_fma_f32 v[94:95], v[94:95], v[8:9], v[50:51] op_sel_hi:[1,0,1]
    v_cvt_pk_bf16_f32 v44, v88, v89
    v_cvt_pk_bf16_f32 v45, v90, v91
    v_cvt_pk_bf16_f32 v46, v92, v93
    v_cvt_pk_bf16_f32 v47, v94, v95
    s_add_u32 s29, s59, 196608
    buffer_store_dwordx4 v[44:47], v200, s[32:35], s29 offen sc1
    v_pk_mul_f32 v[48:49], v[128:129], v[10:11] op_sel:[0,1] op_sel_hi:[1,1]
    v_pk_fma_f32 v[96:97], v[96:97], v[10:11], v[48:49] op_sel_hi:[1,0,1]
    v_pk_mul_f32 v[50:51], v[130:131], v[10:11] op_sel:[0,1] op_sel_hi:[1,1]
    v_pk_fma_f32 v[98:99], v[98:99], v[10:11], v[50:51] op_sel_hi:[1,0,1]
    v_pk_mul_f32 v[48:49], v[132:133], v[10:11] op_sel:[0,1] op_sel_hi:[1,1]
    v_pk_fma_f32 v[100:101], v[100:101], v[10:11], v[48:49] op_sel_hi:[1,0,1]
    v_pk_mul_f32 v[50:51], v[134:135], v[10:11] op_sel:[0,1] op_sel_hi:[1,1]
    v_pk_fma_f32 v[102:103], v[102:103], v[10:11], v[50:51] op_sel_hi:[1,0,1]
    v_cvt_pk_bf16_f32 v32, v96, v97
    v_cvt_pk_bf16_f32 v33, v98, v99
    v_cvt_pk_bf16_f32 v34, v100, v101
    v_cvt_pk_bf16_f32 v35, v102, v103
    s_add_u32 s29, s59, 512
    buffer_store_dwordx4 v[32:35], v200, s[32:35], s29 offen sc1
    v_pk_mul_f32 v[48:49], v[136:137], v[10:11] op_sel:[0,1] op_sel_hi:[1,1]
    v_pk_fma_f32 v[104:105], v[104:105], v[10:11], v[48:49] op_sel_hi:[1,0,1]
    v_pk_mul_f32 v[50:51], v[138:139], v[10:11] op_sel:[0,1] op_sel_hi:[1,1]
    v_pk_fma_f32 v[106:107], v[106:107], v[10:11], v[50:51] op_sel_hi:[1,0,1]
    v_pk_mul_f32 v[48:49], v[140:141], v[10:11] op_sel:[0,1] op_sel_hi:[1,1]
    v_pk_fma_f32 v[108:109], v[108:109], v[10:11], v[48:49] op_sel_hi:[1,0,1]
    v_pk_mul_f32 v[50:51], v[142:143], v[10:11] op_sel:[0,1] op_sel_hi:[1,1]
    v_pk_fma_f32 v[110:111], v[110:111], v[10:11], v[50:51] op_sel_hi:[1,0,1]
    v_cvt_pk_bf16_f32 v36, v104, v105
    v_cvt_pk_bf16_f32 v37, v106, v107
    v_cvt_pk_bf16_f32 v38, v108, v109
    v_cvt_pk_bf16_f32 v39, v110, v111
    s_add_u32 s29, s59, 66048
    buffer_store_dwordx4 v[36:39], v200, s[32:35], s29 offen sc1
    v_pk_mul_f32 v[48:49], v[144:145], v[10:11] op_sel:[0,1] op_sel_hi:[1,1]
    v_pk_fma_f32 v[112:113], v[112:113], v[10:11], v[48:49] op_sel_hi:[1,0,1]
    v_pk_mul_f32 v[50:51], v[146:147], v[10:11] op_sel:[0,1] op_sel_hi:[1,1]
    v_pk_fma_f32 v[114:115], v[114:115], v[10:11], v[50:51] op_sel_hi:[1,0,1]
    v_pk_mul_f32 v[48:49], v[148:149], v[10:11] op_sel:[0,1] op_sel_hi:[1,1]
    v_pk_fma_f32 v[116:117], v[116:117], v[10:11], v[48:49] op_sel_hi:[1,0,1]
    v_pk_mul_f32 v[50:51], v[150:151], v[10:11] op_sel:[0,1] op_sel_hi:[1,1]
    v_pk_fma_f32 v[118:119], v[118:119], v[10:11], v[50:51] op_sel_hi:[1,0,1]
    v_cvt_pk_bf16_f32 v40, v112, v113
    v_cvt_pk_bf16_f32 v41, v114, v115
    v_cvt_pk_bf16_f32 v42, v116, v117
    v_cvt_pk_bf16_f32 v43, v118, v119
    s_add_u32 s29, s59, 131584
    buffer_store_dwordx4 v[40:43], v200, s[32:35], s29 offen sc1
    v_pk_mul_f32 v[48:49], v[152:153], v[10:11] op_sel:[0,1] op_sel_hi:[1,1]
    v_pk_fma_f32 v[120:121], v[120:121], v[10:11], v[48:49] op_sel_hi:[1,0,1]
    v_pk_mul_f32 v[50:51], v[154:155], v[10:11] op_sel:[0,1] op_sel_hi:[1,1]
    v_pk_fma_f32 v[122:123], v[122:123], v[10:11], v[50:51] op_sel_hi:[1,0,1]
    v_pk_mul_f32 v[48:49], v[156:157], v[10:11] op_sel:[0,1] op_sel_hi:[1,1]
    v_pk_fma_f32 v[124:125], v[124:125], v[10:11], v[48:49] op_sel_hi:[1,0,1]
    v_pk_mul_f32 v[50:51], v[158:159], v[10:11] op_sel:[0,1] op_sel_hi:[1,1]
    v_pk_fma_f32 v[126:127], v[126:127], v[10:11], v[50:51] op_sel_hi:[1,0,1]
    v_cvt_pk_bf16_f32 v44, v120, v121
    v_cvt_pk_bf16_f32 v45, v122, v123
    v_cvt_pk_bf16_f32 v46, v124, v125
    v_cvt_pk_bf16_f32 v47, v126, v127
    s_add_u32 s29, s59, 197120
    buffer_store_dwordx4 v[44:47], v200, s[32:35], s29 offen sc1
    s_branch L_p1_stored
L_p1_v:
    ds_read_b128 v[32:35], v8 offset:0
    ds_read_b128 v[36:39], v8 offset:4096
    ds_read_b64_tr_b16 v[40:41], v16 offset:0
    ds_read_b64_tr_b16 v[42:43], v16 offset:1024
    ds_read_b64_tr_b16 v[44:45], v17 offset:0
    ds_read_b64_tr_b16 v[46:47], v17 offset:1024
    ds_read_b128 v[48:51], v9 offset:0
    ds_read_b128 v[52:55], v9 offset:4096
    ds_read_b64_tr_b16 v[56:57], v16 offset:4096
    ds_read_b64_tr_b16 v[58:59], v16 offset:5120
    ds_read_b64_tr_b16 v[60:61], v17 offset:4096
    ds_read_b64_tr_b16 v[62:63], v17 offset:5120
    s_waitcnt lgkmcnt(6)
    v_mfma_f32_32x32x16_bf16 v[64:79], v[32:35], v[40:43], 0
    v_mfma_f32_32x32x16_bf16 v[80:95], v[32:35], v[44:47], 0
    v_mfma_f32_32x32x16_bf16 v[96:111], v[36:39], v[40:43], 0
    v_mfma_f32_32x32x16_bf16 v[112:127], v[36:39], v[44:47], 0
    ds_read_b128 v[32:35], v10 offset:0
    ds_read_b128 v[36:39], v10 offset:4096
    ds_read_b64_tr_b16 v[40:41], v16 offset:8192
    ds_read_b64_tr_b16 v[42:43], v16 offset:9216
    ds_read_b64_tr_b16 v[44:45], v17 offset:8192
    ds_read_b64_tr_b16 v[46:47], v17 offset:9216
    s_waitcnt lgkmcnt(6)
    v_mfma_f32_32x32x16_bf16 v[64:79], v[48:51], v[56:59], v[64:79]
    v_mfma_f32_32x32x16_bf16 v[80:95], v[48:51], v[60:63], v[80:95]
    v_mfma_f32_32x32x16_bf16 v[96:111], v[52:55], v[56:59], v[96:111]
    v_mfma_f32_32x32x16_bf16 v[112:127], v[52:55], v[60:63], v[112:127]
    ds_read_b128 v[48:51], v11 offset:0
    ds_read_b128 v[52:55], v11 offset:4096
    ds_read_b64_tr_b16 v[56:57], v16 offset:12288
    ds_read_b64_tr_b16 v[58:59], v16 offset:13312
    ds_read_b64_tr_b16 v[60:61], v17 offset:12288
    ds_read_b64_tr_b16 v[62:63], v17 offset:13312
    s_waitcnt lgkmcnt(6)
    v_mfma_f32_32x32x16_bf16 v[64:79], v[32:35], v[40:43], v[64:79]
    v_mfma_f32_32x32x16_bf16 v[80:95], v[32:35], v[44:47], v[80:95]
    v_mfma_f32_32x32x16_bf16 v[96:111], v[36:39], v[40:43], v[96:111]
    v_mfma_f32_32x32x16_bf16 v[112:127], v[36:39], v[44:47], v[112:127]
    s_barrier
    ds_read_b128 v[32:35], v8 offset:32768
    ds_read_b128 v[36:39], v8 offset:36864
    ds_read_b64_tr_b16 v[40:41], v16 offset:32768
    ds_read_b64_tr_b16 v[42:43], v16 offset:33792
    ds_read_b64_tr_b16 v[44:45], v17 offset:32768
    ds_read_b64_tr_b16 v[46:47], v17 offset:33792
    s_waitcnt lgkmcnt(6)
    v_mfma_f32_32x32x16_bf16 v[64:79], v[48:51], v[56:59], v[64:79]
    v_mfma_f32_32x32x16_bf16 v[80:95], v[48:51], v[60:63], v[80:95]
    v_mfma_f32_32x32x16_bf16 v[96:111], v[52:55], v[56:59], v[96:111]
    v_mfma_f32_32x32x16_bf16 v[112:127], v[52:55], v[60:63], v[112:127]
    ds_read_b128 v[48:51], v9 offset:32768
    ds_read_b128 v[52:55], v9 offset:36864
    ds_read_b64_tr_b16 v[56:57], v16 offset:36864
    ds_read_b64_tr_b16 v[58:59], v16 offset:37888
    ds_read_b64_tr_b16 v[60:61], v17 offset:36864
    ds_read_b64_tr_b16 v[62:63], v17 offset:37888
    s_waitcnt lgkmcnt(6)
    v_mfma_f32_32x32x16_bf16 v[64:79], v[32:35], v[40:43], v[64:79]
    v_mfma_f32_32x32x16_bf16 v[80:95], v[32:35], v[44:47], v[80:95]
    v_mfma_f32_32x32x16_bf16 v[96:111], v[36:39], v[40:43], v[96:111]
    v_mfma_f32_32x32x16_bf16 v[112:127], v[36:39], v[44:47], v[112:127]
    ds_read_b128 v[32:35], v10 offset:32768
    ds_read_b128 v[36:39], v10 offset:36864
    ds_read_b64_tr_b16 v[40:41], v16 offset:40960
    ds_read_b64_tr_b16 v[42:43], v16 offset:41984
    ds_read_b64_tr_b16 v[44:45], v17 offset:40960
    ds_read_b64_tr_b16 v[46:47], v17 offset:41984
    s_waitcnt lgkmcnt(6)
    v_mfma_f32_32x32x16_bf16 v[64:79], v[48:51], v[56:59], v[64:79]
    v_mfma_f32_32x32x16_bf16 v[80:95], v[48:51], v[60:63], v[80:95]
    v_mfma_f32_32x32x16_bf16 v[96:111], v[52:55], v[56:59], v[96:111]
    v_mfma_f32_32x32x16_bf16 v[112:127], v[52:55], v[60:63], v[112:127]
    v_mov_b32 v220, 0
    v_mov_b32 v221, 0
    v_mov_b32 v222, 0
    v_mov_b32 v223, 0
    s_mov_b32 s30, 1065369472
    s_waitcnt vmcnt(10)
    v_dot2_f32_bf16 v220, v190, s30, v220
    v_dot2_f32_bf16 v221, v190, v190, v221
    v_dot2_f32_bf16 v222, v190, v200, v222
    v_dot2_f32_bf16 v223, v200, s30, v223
    v_dot2_f32_bf16 v220, v191, s30, v220
    v_dot2_f32_bf16 v221, v191, v191, v221
    v_dot2_f32_bf16 v222, v191, v201, v222
    v_dot2_f32_bf16 v223, v201, s30, v223
    v_dot2_f32_bf16 v220, v192, s30, v220
    v_dot2_f32_bf16 v221, v192, v192, v221
    v_dot2_f32_bf16 v222, v192, v202, v222
    v_dot2_f32_bf16 v223, v202, s30, v223
    v_dot2_f32_bf16 v220, v193, s30, v220
    v_dot2_f32_bf16 v221, v193, v193, v221
    v_dot2_f32_bf16 v222, v193, v203, v222
    v_dot2_f32_bf16 v223, v203, s30, v223
    v_dot2_f32_bf16 v220, v194, s30, v220
    v_dot2_f32_bf16 v221, v194, v194, v221
    v_dot2_f32_bf16 v222, v194, v204, v222
    v_dot2_f32_bf16 v223, v204, s30, v223
    v_dot2_f32_bf16 v220, v195, s30, v220
    v_dot2_f32_bf16 v221, v195, v195, v221
    v_dot2_f32_bf16 v222, v195, v205, v222
    v_dot2_f32_bf16 v223, v205, s30, v223
    v_dot2_f32_bf16 v220, v196, s30, v220
    v_dot2_f32_bf16 v221, v196, v196, v221
    v_dot2_f32_bf16 v222, v196, v206, v222
    v_dot2_f32_bf16 v223, v206, s30, v223
    v_dot2_f32_bf16 v220, v197, s30, v220
    v_dot2_f32_bf16 v221, v197, v197, v221
    v_dot2_f32_bf16 v222, v197, v207, v222
    v_dot2_f32_bf16 v223, v207, s30, v223
    v_dot2_f32_bf16 v220, v198, s30, v220
    v_dot2_f32_bf16 v221, v198, v198, v221
    v_dot2_f32_bf16 v222, v198, v208, v222
    v_dot2_f32_bf16 v223, v208, s30, v223
    v_dot2_f32_bf16 v220, v199, s30, v220
    v_dot2_f32_bf16 v221, v199, v199, v221
    v_dot2_f32_bf16 v222, v199, v209, v222
    v_dot2_f32_bf16 v223, v209, s30, v223
    s_nop 3
    v_add_f32_dpp v220, v220, v220 row_shr:1 row_mask:0xf bank_mask:0xf
    v_add_f32_dpp v221, v221, v221 row_shr:1 row_mask:0xf bank_mask:0xf
    v_add_f32_dpp v222, v222, v222 row_shr:1 row_mask:0xf bank_mask:0xf
    v_add_f32_dpp v223, v223, v223 row_shr:1 row_mask:0xf bank_mask:0xf
    v_add_f32_dpp v220, v220, v220 row_shr:2 row_mask:0xf bank_mask:0xf
    v_add_f32_dpp v221, v221, v221 row_shr:2 row_mask:0xf bank_mask:0xf
    v_add_f32_dpp v222, v222, v222 row_shr:2 row_mask:0xf bank_mask:0xf
    v_add_f32_dpp v223, v223, v223 row_shr:2 row_mask:0xf bank_mask:0xf
    v_add_f32_dpp v220, v220, v220 row_shr:4 row_mask:0xf bank_mask:0xf
    v_add_f32_dpp v221, v221, v221 row_shr:4 row_mask:0xf bank_mask:0xf
    v_add_f32_dpp v222, v222, v222 row_shr:4 row_mask:0xf bank_mask:0xf
    v_add_f32_dpp v223, v223, v223 row_shr:4 row_mask:0xf bank_mask:0xf
    v_add_f32_dpp v220, v220, v220 row_shr:8 row_mask:0xf bank_mask:0xf
    v_add_f32_dpp v221, v221, v221 row_shr:8 row_mask:0xf bank_mask:0xf
    v_add_f32_dpp v222, v222, v222 row_shr:8 row_mask:0xf bank_mask:0xf
    v_add_f32_dpp v223, v223, v223 row_shr:8 row_mask:0xf bank_mask:0xf
    v_add_f32_dpp v220, v220, v220 row_bcast:15 row_mask:0xa bank_mask:0xf
    v_add_f32_dpp v221, v221, v221 row_bcast:15 row_mask:0xa bank_mask:0xf
    v_add_f32_dpp v222, v222, v222 row_bcast:15 row_mask:0xa bank_mask:0xf
    v_add_f32_dpp v223, v223, v223 row_bcast:15 row_mask:0xa bank_mask:0xf
    s_mov_b32 s30, 0x3acccccd
    v_mul_f32 v160, s30, v220
    v_mul_f32 v221, s30, v221
    v_fma_f32 v221, -v160, v160, v221
    v_max_f32 v221, 0, v221
    v_add_f32 v221, 0x3727c5ac, v221
    v_rsq_f32 v161, v221
    v_fma_f32 v222, -v160, v223, v222
    s_nop 0
    v_mul_f32 v162, v222, v161
    v_ashrrev_i32 v220, 31, v162
    v_or_b32 v220, 0x80000000, v220
    v_xor_b32 v220, v220, v162
    v_and_b32 v220, 0xfffff800, v220
    v_or_b32 v163, v220, v164
    ds_read_b128 v[48:51], v11 offset:32768
    ds_read_b128 v[52:55], v11 offset:36864
    ds_read_b64_tr_b16 v[56:57], v16 offset:45056
    ds_read_b64_tr_b16 v[58:59], v16 offset:46080
    ds_read_b64_tr_b16 v[60:61], v17 offset:45056
    ds_read_b64_tr_b16 v[62:63], v17 offset:46080
    s_waitcnt lgkmcnt(6)
    v_mfma_f32_32x32x16_bf16 v[64:79], v[32:35], v[40:43], v[64:79]
    v_mfma_f32_32x32x16_bf16 v[80:95], v[32:35], v[44:47], v[80:95]
    v_mfma_f32_32x32x16_bf16 v[96:111], v[36:39], v[40:43], v[96:111]
    v_mfma_f32_32x32x16_bf16 v[112:127], v[36:39], v[44:47], v[112:127]
    v_mov_b32 v220, 0
    v_mov_b32 v221, 0
    s_mov_b32 s30, 0x00003f80
    s_mov_b32 s31, 0x3f800000
    s_waitcnt vmcnt(0)
    v_dot2_f32_bf16 v220, v210, s30, v220
    v_dot2_f32_bf16 v221, v210, s31, v221
    v_dot2_f32_bf16 v220, v211, s30, v220
    v_dot2_f32_bf16 v221, v211, s31, v221
    v_dot2_f32_bf16 v220, v212, s30, v220
    v_dot2_f32_bf16 v221, v212, s31, v221
    v_dot2_f32_bf16 v220, v213, s30, v220
    v_dot2_f32_bf16 v221, v213, s31, v221
    v_dot2_f32_bf16 v220, v214, s30, v220
    v_dot2_f32_bf16 v221, v214, s31, v221
    v_dot2_f32_bf16 v220, v215, s30, v220
    v_dot2_f32_bf16 v221, v215, s31, v221
    v_dot2_f32_bf16 v220, v216, s30, v220
    v_dot2_f32_bf16 v221, v216, s31, v221
    v_dot2_f32_bf16 v220, v217, s30, v220
    v_dot2_f32_bf16 v221, v217, s31, v221
    v_dot2_f32_bf16 v220, v218, s30, v220
    v_dot2_f32_bf16 v221, v218, s31, v221
    v_dot2_f32_bf16 v220, v219, s30, v220
    v_dot2_f32_bf16 v221, v219, s31, v221
    s_lshl_b32 s29, s3, 9
    s_add_u32 s29, s29, 157696
    v_lshlrev_b32 v222, 3, v255
    v_add_u32 v222, s29, v222
    s_nop 1
    ds_write_b64 v222, v[220:221]
    s_waitcnt lgkmcnt(0)
    s_barrier
    ds_read_b128 v[32:35], v12 offset:0
    ds_read_b128 v[36:39], v12 offset:4096
    ds_read_b64_tr_b16 v[40:41], v18 offset:0
    ds_read_b64_tr_b16 v[42:43], v18 offset:1024
    ds_read_b64_tr_b16 v[44:45], v19 offset:0
    ds_read_b64_tr_b16 v[46:47], v19 offset:1024
    s_waitcnt lgkmcnt(6)
    v_mfma_f32_32x32x16_bf16 v[64:79], v[48:51], v[56:59], v[64:79]
    v_mfma_f32_32x32x16_bf16 v[80:95], v[48:51], v[60:63], v[80:95]
    v_mfma_f32_32x32x16_bf16 v[96:111], v[52:55], v[56:59], v[96:111]
    v_mfma_f32_32x32x16_bf16 v[112:127], v[52:55], v[60:63], v[112:127]
    ds_read_b128 v[48:51], v13 offset:0
    ds_read_b128 v[52:55], v13 offset:4096
    ds_read_b64_tr_b16 v[56:57], v18 offset:4096
    ds_read_b64_tr_b16 v[58:59], v18 offset:5120
    ds_read_b64_tr_b16 v[60:61], v19 offset:4096
    ds_read_b64_tr_b16 v[62:63], v19 offset:5120
    s_waitcnt lgkmcnt(6)
    v_mfma_f32_32x32x16_bf16 v[64:79], v[32:35], v[40:43], v[64:79]
    v_mfma_f32_32x32x16_bf16 v[80:95], v[32:35], v[44:47], v[80:95]
    v_mfma_f32_32x32x16_bf16 v[96:111], v[36:39], v[40:43], v[96:111]
    v_mfma_f32_32x32x16_bf16 v[112:127], v[36:39], v[44:47], v[112:127]
    v_mov_b32 v170, 0
    buffer_load_dword v171, v170, s[52:55], 0 offen sc1
    ds_read_b128 v[32:35], v14 offset:0
    ds_read_b128 v[36:39], v14 offset:4096
    ds_read_b64_tr_b16 v[40:41], v18 offset:8192
    ds_read_b64_tr_b16 v[42:43], v18 offset:9216
    ds_read_b64_tr_b16 v[44:45], v19 offset:8192
    ds_read_b64_tr_b16 v[46:47], v19 offset:9216
    s_waitcnt lgkmcnt(6)
    v_mfma_f32_32x32x16_bf16 v[64:79], v[48:51], v[56:59], v[64:79]
    v_mfma_f32_32x32x16_bf16 v[80:95], v[48:51], v[60:63], v[80:95]
    v_mfma_f32_32x32x16_bf16 v[96:111], v[52:55], v[56:59], v[96:111]
    v_mfma_f32_32x32x16_bf16 v[112:127], v[52:55], v[60:63], v[112:127]
    ds_read_b128 v[48:51], v15 offset:0
    ds_read_b128 v[52:55], v15 offset:4096
    ds_read_b64_tr_b16 v[56:57], v18 offset:12288
    ds_read_b64_tr_b16 v[58:59], v18 offset:13312
    ds_read_b64_tr_b16 v[60:61], v19 offset:12288
    ds_read_b64_tr_b16 v[62:63], v19 offset:13312
    s_waitcnt lgkmcnt(6)
    v_mfma_f32_32x32x16_bf16 v[64:79], v[32:35], v[40:43], v[64:79]
    v_mfma_f32_32x32x16_bf16 v[80:95], v[32:35], v[44:47], v[80:95]
    v_mfma_f32_32x32x16_bf16 v[96:111], v[36:39], v[40:43], v[96:111]
    v_mfma_f32_32x32x16_bf16 v[112:127], v[36:39], v[44:47], v[112:127]
    s_barrier
    ds_read_b128 v[32:35], v12 offset:32768
    ds_read_b128 v[36:39], v12 offset:36864
    ds_read_b64_tr_b16 v[40:41], v18 offset:32768
    ds_read_b64_tr_b16 v[42:43], v18 offset:33792
    ds_read_b64_tr_b16 v[44:45], v19 offset:32768
    ds_read_b64_tr_b16 v[46:47], v19 offset:33792
    s_waitcnt lgkmcnt(6)
    v_mfma_f32_32x32x16_bf16 v[64:79], v[48:51], v[56:59], v[64:79]
    v_mfma_f32_32x32x16_bf16 v[80:95], v[48:51], v[60:63], v[80:95]
    v_mfma_f32_32x32x16_bf16 v[96:111], v[52:55], v[56:59], v[96:111]
    v_mfma_f32_32x32x16_bf16 v[112:127], v[52:55], v[60:63], v[112:127]
    ds_read_b128 v[48:51], v13 offset:32768
    ds_read_b128 v[52:55], v13 offset:36864
    ds_read_b64_tr_b16 v[56:57], v18 offset:36864
    ds_read_b64_tr_b16 v[58:59], v18 offset:37888
    ds_read_b64_tr_b16 v[60:61], v19 offset:36864
    ds_read_b64_tr_b16 v[62:63], v19 offset:37888
    s_waitcnt lgkmcnt(6)
    v_mfma_f32_32x32x16_bf16 v[64:79], v[32:35], v[40:43], v[64:79]
    v_mfma_f32_32x32x16_bf16 v[80:95], v[32:35], v[44:47], v[80:95]
    v_mfma_f32_32x32x16_bf16 v[96:111], v[36:39], v[40:43], v[96:111]
    v_mfma_f32_32x32x16_bf16 v[112:127], v[36:39], v[44:47], v[112:127]
    ds_read_b128 v[32:35], v14 offset:32768
    ds_read_b128 v[36:39], v14 offset:36864
    ds_read_b64_tr_b16 v[40:41], v18 offset:40960
    ds_read_b64_tr_b16 v[42:43], v18 offset:41984
    ds_read_b64_tr_b16 v[44:45], v19 offset:40960
    ds_read_b64_tr_b16 v[46:47], v19 offset:41984
    s_waitcnt lgkmcnt(6)
    v_mfma_f32_32x32x16_bf16 v[64:79], v[48:51], v[56:59], v[64:79]
    v_mfma_f32_32x32x16_bf16 v[80:95], v[48:51], v[60:63], v[80:95]
    v_mfma_f32_32x32x16_bf16 v[96:111], v[52:55], v[56:59], v[96:111]
    v_mfma_f32_32x32x16_bf16 v[112:127], v[52:55], v[60:63], v[112:127]
    ds_read_b128 v[48:51], v15 offset:32768
    ds_read_b128 v[52:55], v15 offset:36864
    ds_read_b64_tr_b16 v[56:57], v18 offset:45056
    ds_read_b64_tr_b16 v[58:59], v18 offset:46080
    ds_read_b64_tr_b16 v[60:61], v19 offset:45056
    ds_read_b64_tr_b16 v[62:63], v19 offset:46080
    s_waitcnt lgkmcnt(6)
    v_mfma_f32_32x32x16_bf16 v[64:79], v[32:35], v[40:43], v[64:79]
    v_mfma_f32_32x32x16_bf16 v[80:95], v[32:35], v[44:47], v[80:95]
    v_mfma_f32_32x32x16_bf16 v[96:111], v[36:39], v[40:43], v[96:111]
    v_mfma_f32_32x32x16_bf16 v[112:127], v[36:39], v[44:47], v[112:127]
    s_barrier
    ds_read_b128 v[32:35], v8 offset:0
    ds_read_b128 v[36:39], v8 offset:4096
    ds_read_b64_tr_b16 v[40:41], v16 offset:0
    ds_read_b64_tr_b16 v[42:43], v16 offset:1024
    ds_read_b64_tr_b16 v[44:45], v17 offset:0
    ds_read_b64_tr_b16 v[46:47], v17 offset:1024
    s_waitcnt lgkmcnt(6)
    v_mfma_f32_32x32x16_bf16 v[64:79], v[48:51], v[56:59], v[64:79]
    v_mfma_f32_32x32x16_bf16 v[80:95], v[48:51], v[60:63], v[80:95]
    v_mfma_f32_32x32x16_bf16 v[96:111], v[52:55], v[56:59], v[96:111]
    v_mfma_f32_32x32x16_bf16 v[112:127], v[52:55], v[60:63], v[112:127]
    ds_read_b128 v[48:51], v9 offset:0
    ds_read_b128 v[52:55], v9 offset:4096
    ds_read_b64_tr_b16 v[56:57], v16 offset:4096
    ds_read_b64_tr_b16 v[58:59], v16 offset:5120
    ds_read_b64_tr_b16 v[60:61], v17 offset:4096
    ds_read_b64_tr_b16 v[62:63], v17 offset:5120
    s_waitcnt lgkmcnt(6)
    v_mfma_f32_32x32x16_bf16 v[64:79], v[32:35], v[40:43], v[64:79]
    v_mfma_f32_32x32x16_bf16 v[80:95], v[32:35], v[44:47], v[80:95]
    v_mfma_f32_32x32x16_bf16 v[96:111], v[36:39], v[40:43], v[96:111]
    v_mfma_f32_32x32x16_bf16 v[112:127], v[36:39], v[44:47], v[112:127]
    s_waitcnt vmcnt(0)
    v_readfirstlane_b32 s26, v171
    s_cmp_lg_u32 s26, 0
    s_cbranch_scc1 L_p1v_nonce_ok
    v_mov_b32 v170, 0
    s_mov_b32 s67, 200000
L_p1v_nonce:
    buffer_load_dword v171, v170, s[52:55], 0 offen sc1
    s_waitcnt vmcnt(0)
    v_readfirstlane_b32 s26, v171
    s_cmp_lg_u32 s26, 0
    s_cbranch_scc1 L_p1v_nonce_ok
    s_sleep 2
    s_sub_u32 s67, s67, 1
    s_cmp_lg_u32 s67, 0
    s_cbranch_scc1 L_p1v_nonce
L_p1v_nonce_ok:
    v_mov_b32 v170, 163328
    v_mov_b32 v171, s26
    ds_write_b32 v170, v171
    s_add_u32 s32, s24, 0xa04600
    s_addc_u32 s33, s25, 0
    s_mov_b32 s34, 0x8000
    s_mov_b32 s35, 0x00020000
    s_add_u32 s36, s24, 0xa50800
    s_addc_u32 s37, s25, 0
    s_mov_b32 s38, 0x8000
    s_mov_b32 s39, 0x00020000
    v_mov_b32 v172, v160
    v_mov_b32 v173, s26
    v_mov_b32 v174, v161
    v_mov_b32 v175, s26
    v_lshlrev_b32 v176, 3, v164
    v_lshlrev_b32 v177, 2, v164
    v_lshlrev_b32 v178, 4, v164
    s_mov_b32 s29, 16384
    s_mov_b32 s30, 24576
    v_and_b32 v179, 31, v255
    v_cmp_eq_u32 vcc, 31, v179
    s_and_saveexec_b64 s[56:57], vcc
    buffer_store_dwordx4 v[172:175], v178, s[36:39], 0 offen sc1
    buffer_store_dwordx2 v[160:161], v176, s[32:35], 0 offen sc1
    buffer_store_dword v162, v177, s[32:35], s29 offen sc1
    buffer_store_dword v163, v177, s[32:35], s30 offen sc1
    s_mov_b64 exec, s[56:57]
    s_cmp_lg_u32 s3, 0
    s_cbranch_scc1 L_p1v_nocs
    v_lshlrev_b32 v192, 3, v255
    v_add_u32 v193, 157696, v192
    ds_read_b64 v[184:185], v193
    ds_read_b64 v[186:187], v193 offset:512
    ds_read_b64 v[188:189], v193 offset:1024
    ds_read_b64 v[190:191], v193 offset:1536
    s_add_u32 s32, s24, 0xa0c600
    s_addc_u32 s33, s25, 0
    s_mov_b32 s34, 0x40000
    s_mov_b32 s35, 0x00020000
    s_lshl_b32 s29, s28, 4
    s_add_u32 s29, s29, s27
    s_lshl_b32 s29, s29, 10
    v_lshlrev_b32 v192, 4, v255
    s_waitcnt lgkmcnt(0)
    v_add_f32 v184, v184, v186
    v_add_f32 v185, v185, v187
    v_add_f32 v188, v188, v190
    v_add_f32 v189, v189, v191
    v_add_f32 v184, v184, v188
    v_add_f32 v186, v185, v189
    v_mov_b32 v185, s26
    v_mov_b32 v187, s26
    buffer_store_dwordx4 v[184:187], v192, s[32:35], s29 offen sc1
L_p1v_nocs:
    s_waitcnt lgkmcnt(0)
    ds_read_b128 v[32:35], v10 offset:0
    ds_read_b128 v[36:39], v10 offset:4096
    ds_read_b64_tr_b16 v[40:41], v16 offset:8192
    ds_read_b64_tr_b16 v[42:43], v16 offset:9216
    ds_read_b64_tr_b16 v[44:45], v17 offset:8192
    ds_read_b64_tr_b16 v[46:47], v17 offset:9216
    s_waitcnt lgkmcnt(6)
    v_mfma_f32_32x32x16_bf16 v[64:79], v[48:51], v[56:59], v[64:79]
    v_mfma_f32_32x32x16_bf16 v[80:95], v[48:51], v[60:63], v[80:95]
    v_mfma_f32_32x32x16_bf16 v[96:111], v[52:55], v[56:59], v[96:111]
    v_mfma_f32_32x32x16_bf16 v[112:127], v[52:55], v[60:63], v[112:127]
    ds_read_b128 v[48:51], v11 offset:0
    ds_read_b128 v[52:55], v11 offset:4096
    ds_read_b64_tr_b16 v[56:57], v16 offset:12288
    ds_read_b64_tr_b16 v[58:59], v16 offset:13312
    ds_read_b64_tr_b16 v[60:61], v17 offset:12288
    ds_read_b64_tr_b16 v[62:63], v17 offset:13312
    s_waitcnt lgkmcnt(6)
    v_mfma_f32_32x32x16_bf16 v[64:79], v[32:35], v[40:43], v[64:79]
    v_mfma_f32_32x32x16_bf16 v[80:95], v[32:35], v[44:47], v[80:95]
    v_mfma_f32_32x32x16_bf16 v[96:111], v[36:39], v[40:43], v[96:111]
    v_mfma_f32_32x32x16_bf16 v[112:127], v[36:39], v[44:47], v[112:127]
    s_barrier
    ds_read_b128 v[32:35], v8 offset:32768
    ds_read_b128 v[36:39], v8 offset:36864
    ds_read_b64_tr_b16 v[40:41], v16 offset:32768
    ds_read_b64_tr_b16 v[42:43], v16 offset:33792
    ds_read_b64_tr_b16 v[44:45], v17 offset:32768
    ds_read_b64_tr_b16 v[46:47], v17 offset:33792
    s_waitcnt lgkmcnt(6)
    v_mfma_f32_32x32x16_bf16 v[64:79], v[48:51], v[56:59], v[64:79]
    v_mfma_f32_32x32x16_bf16 v[80:95], v[48:51], v[60:63], v[80:95]
    v_mfma_f32_32x32x16_bf16 v[96:111], v[52:55], v[56:59], v[96:111]
    v_mfma_f32_32x32x16_bf16 v[112:127], v[52:55], v[60:63], v[112:127]
    ds_read_b128 v[48:51], v9 offset:32768
    ds_read_b128 v[52:55], v9 offset:36864
    ds_read_b64_tr_b16 v[56:57], v16 offset:36864
    ds_read_b64_tr_b16 v[58:59], v16 offset:37888
    ds_read_b64_tr_b16 v[60:61], v17 offset:36864
    ds_read_b64_tr_b16 v[62:63], v17 offset:37888
    s_waitcnt lgkmcnt(6)
    v_mfma_f32_32x32x16_bf16 v[64:79], v[32:35], v[40:43], v[64:79]
    v_mfma_f32_32x32x16_bf16 v[80:95], v[32:35], v[44:47], v[80:95]
    v_mfma_f32_32x32x16_bf16 v[96:111], v[36:39], v[40:43], v[96:111]
    v_mfma_f32_32x32x16_bf16 v[112:127], v[36:39], v[44:47], v[112:127]
    ds_read_b128 v[32:35], v10 offset:32768
    ds_read_b128 v[36:39], v10 offset:36864
    ds_read_b64_tr_b16 v[40:41], v16 offset:40960
    ds_read_b64_tr_b16 v[42:43], v16 offset:41984
    ds_read_b64_tr_b16 v[44:45], v17 offset:40960
    ds_read_b64_tr_b16 v[46:47], v17 offset:41984
    s_waitcnt lgkmcnt(6)
    v_mfma_f32_32x32x16_bf16 v[64:79], v[48:51], v[56:59], v[64:79]
    v_mfma_f32_32x32x16_bf16 v[80:95], v[48:51], v[60:63], v[80:95]
    v_mfma_f32_32x32x16_bf16 v[96:111], v[52:55], v[56:59], v[96:111]
    v_mfma_f32_32x32x16_bf16 v[112:127], v[52:55], v[60:63], v[112:127]
    ds_read_b128 v[48:51], v11 offset:32768
    ds_read_b128 v[52:55], v11 offset:36864
    ds_read_b64_tr_b16 v[56:57], v16 offset:45056
    ds_read_b64_tr_b16 v[58:59], v16 offset:46080
    ds_read_b64_tr_b16 v[60:61], v17 offset:45056
    ds_read_b64_tr_b16 v[62:63], v17 offset:46080
    s_waitcnt lgkmcnt(6)
    v_mfma_f32_32x32x16_bf16 v[64:79], v[32:35], v[40:43], v[64:79]
    v_mfma_f32_32x32x16_bf16 v[80:95], v[32:35], v[44:47], v[80:95]
    v_mfma_f32_32x32x16_bf16 v[96:111], v[36:39], v[40:43], v[96:111]
    v_mfma_f32_32x32x16_bf16 v[112:127], v[36:39], v[44:47], v[112:127]
    s_barrier
    ds_read_b128 v[32:35], v12 offset:0
    ds_read_b128 v[36:39], v12 offset:4096
    ds_read_b64_tr_b16 v[40:41], v18 offset:0
    ds_read_b64_tr_b16 v[42:43], v18 offset:1024
    ds_read_b64_tr_b16 v[44:45], v19 offset:0
    ds_read_b64_tr_b16 v[46:47], v19 offset:1024
    s_waitcnt lgkmcnt(6)
    v_mfma_f32_32x32x16_bf16 v[64:79], v[48:51], v[56:59], v[64:79]
    v_mfma_f32_32x32x16_bf16 v[80:95], v[48:51], v[60:63], v[80:95]
    v_mfma_f32_32x32x16_bf16 v[96:111], v[52:55], v[56:59], v[96:111]
    v_mfma_f32_32x32x16_bf16 v[112:127], v[52:55], v[60:63], v[112:127]
    s_add_u32 s32, s24, 0x500300
    s_addc_u32 s33, s25, 0
    s_mov_b32 s34, 0x284000
    s_mov_b32 s35, 0x00020000
    v_and_b32 v3, 31, v255
    v_lshrrev_b32 v4, 5, v255
    s_lshr_b32 s58, s3, 1
    s_lshl_b32 s29, s58, 6
    v_add_u32 v5, s29, v3
    v_lshlrev_b32 v202, 2, v5
    v_add_u32 v202, 161792, v202
    s_and_b32 s29, s3, 1
    s_lshl_b32 s29, s29, 8
    v_lshlrev_b32 v201, 4, v4
    v_add_u32 v201, s29, v201
    v_add_u32 v201, 162304, v201
    s_sub_u32 s57, s28, 10
    s_lshl_b32 s29, s57, 7
    v_add_u32 v5, s29, v5
    v_lshlrev_b32 v5, 5, v5
    v_lshl_add_u32 v200, v4, 4, v5
    s_lshl_b32 s59, s27, 2
    s_and_b32 s29, s3, 1
    s_lshl_b32 s29, s29, 1
    s_add_u32 s59, s59, s29
    s_mul_i32 s59, s59, 41216
    ds_read_b128 v[48:51], v13 offset:0
    ds_read_b128 v[52:55], v13 offset:4096
    ds_read_b64_tr_b16 v[56:57], v18 offset:4096
    ds_read_b64_tr_b16 v[58:59], v18 offset:5120
    ds_read_b64_tr_b16 v[60:61], v19 offset:4096
    ds_read_b64_tr_b16 v[62:63], v19 offset:5120
    s_waitcnt lgkmcnt(6)
    v_mfma_f32_32x32x16_bf16 v[64:79], v[32:35], v[40:43], v[64:79]
    v_mfma_f32_32x32x16_bf16 v[80:95], v[32:35], v[44:47], v[80:95]
    v_mfma_f32_32x32x16_bf16 v[96:111], v[36:39], v[40:43], v[96:111]
    v_mfma_f32_32x32x16_bf16 v[112:127], v[36:39], v[44:47], v[112:127]
    ds_read_b128 v[32:35], v14 offset:0
    ds_read_b128 v[36:39], v14 offset:4096
    ds_read_b64_tr_b16 v[40:41], v18 offset:8192
    ds_read_b64_tr_b16 v[42:43], v18 offset:9216
    ds_read_b64_tr_b16 v[44:45], v19 offset:8192
    ds_read_b64_tr_b16 v[46:47], v19 offset:9216
    s_waitcnt lgkmcnt(6)
    v_mfma_f32_32x32x16_bf16 v[64:79], v[48:51], v[56:59], v[64:79]
    v_mfma_f32_32x32x16_bf16 v[80:95], v[48:51], v[60:63], v[80:95]
    v_mfma_f32_32x32x16_bf16 v[96:111], v[52:55], v[56:59], v[96:111]
    v_mfma_f32_32x32x16_bf16 v[112:127], v[52:55], v[60:63], v[112:127]
    ds_read_b128 v[48:51], v15 offset:0
    ds_read_b128 v[52:55], v15 offset:4096
    ds_read_b64_tr_b16 v[56:57], v18 offset:12288
    ds_read_b64_tr_b16 v[58:59], v18 offset:13312
    ds_read_b64_tr_b16 v[60:61], v19 offset:12288
    ds_read_b64_tr_b16 v[62:63], v19 offset:13312
    s_waitcnt lgkmcnt(6)
    v_mfma_f32_32x32x16_bf16 v[64:79], v[32:35], v[40:43], v[64:79]
    v_mfma_f32_32x32x16_bf16 v[80:95], v[32:35], v[44:47], v[80:95]
    v_mfma_f32_32x32x16_bf16 v[96:111], v[36:39], v[40:43], v[96:111]
    v_mfma_f32_32x32x16_bf16 v[112:127], v[36:39], v[44:47], v[112:127]
    s_waitcnt vmcnt(0)
    s_barrier
    s_cmp_lg_u32 s3, 0
    s_cbranch_scc1 L_p1v_nof0
    s_add_u32 s52, s24, 0xa58800
    s_addc_u32 s53, s25, 0
    s_mov_b32 s54, 0x8000
    s_mov_b32 s55, 0x00020000
    s_lshl_b32 s29, s2, 7
    v_mov_b32 v28, s29
    v_mov_b32 v29, s26
    s_mov_b64 s[30:31], exec
    s_mov_b64 exec, 1
    buffer_store_dword v29, v28, s[52:55], 0 offen sc1
    s_mov_b64 exec, s[30:31]
L_p1v_nof0:
    ds_read_b128 v[32:35], v12 offset:32768
    ds_read_b128 v[36:39], v12 offset:36864
    ds_read_b64_tr_b16 v[40:41], v18 offset:32768
    ds_read_b64_tr_b16 v[42:43], v18 offset:33792
    ds_read_b64_tr_b16 v[44:45], v19 offset:32768
    ds_read_b64_tr_b16 v[46:47], v19 offset:33792
    s_waitcnt lgkmcnt(6)
    v_mfma_f32_32x32x16_bf16 v[64:79], v[48:51], v[56:59], v[64:79]
    v_mfma_f32_32x32x16_bf16 v[80:95], v[48:51], v[60:63], v[80:95]
    v_mfma_f32_32x32x16_bf16 v[96:111], v[52:55], v[56:59], v[96:111]
    v_mfma_f32_32x32x16_bf16 v[112:127], v[52:55], v[60:63], v[112:127]
    ds_read_b128 v[48:51], v13 offset:32768
    ds_read_b128 v[52:55], v13 offset:36864
    ds_read_b64_tr_b16 v[56:57], v18 offset:36864
    ds_read_b64_tr_b16 v[58:59], v18 offset:37888
    ds_read_b64_tr_b16 v[60:61], v19 offset:36864
    ds_read_b64_tr_b16 v[62:63], v19 offset:37888
    s_waitcnt lgkmcnt(6)
    v_mfma_f32_32x32x16_bf16 v[64:79], v[32:35], v[40:43], v[64:79]
    v_mfma_f32_32x32x16_bf16 v[80:95], v[32:35], v[44:47], v[80:95]
    v_mfma_f32_32x32x16_bf16 v[96:111], v[36:39], v[40:43], v[96:111]
    v_mfma_f32_32x32x16_bf16 v[112:127], v[36:39], v[44:47], v[112:127]
    ds_read_b128 v[32:35], v14 offset:32768
    ds_read_b128 v[36:39], v14 offset:36864
    ds_read_b64_tr_b16 v[40:41], v18 offset:40960
    ds_read_b64_tr_b16 v[42:43], v18 offset:41984
    ds_read_b64_tr_b16 v[44:45], v19 offset:40960
    ds_read_b64_tr_b16 v[46:47], v19 offset:41984
    s_waitcnt lgkmcnt(6)
    v_mfma_f32_32x32x16_bf16 v[64:79], v[48:51], v[56:59], v[64:79]
    v_mfma_f32_32x32x16_bf16 v[80:95], v[48:51], v[60:63], v[80:95]
    v_mfma_f32_32x32x16_bf16 v[96:111], v[52:55], v[56:59], v[96:111]
    v_mfma_f32_32x32x16_bf16 v[112:127], v[52:55], v[60:63], v[112:127]
    ds_read_b128 v[48:51], v15 offset:32768
    ds_read_b128 v[52:55], v15 offset:36864
    ds_read_b64_tr_b16 v[56:57], v18 offset:45056
    ds_read_b64_tr_b16 v[58:59], v18 offset:46080
    ds_read_b64_tr_b16 v[60:61], v19 offset:45056
    ds_read_b64_tr_b16 v[62:63], v19 offset:46080
    s_waitcnt lgkmcnt(6)
    v_mfma_f32_32x32x16_bf16 v[64:79], v[32:35], v[40:43], v[64:79]
    v_mfma_f32_32x32x16_bf16 v[80:95], v[32:35], v[44:47], v[80:95]
    v_mfma_f32_32x32x16_bf16 v[96:111], v[36:39], v[40:43], v[96:111]
    v_mfma_f32_32x32x16_bf16 v[112:127], v[36:39], v[44:47], v[112:127]
    s_barrier
    ds_read_b128 v[32:35], v8 offset:0
    ds_read_b128 v[36:39], v8 offset:4096
    ds_read_b64_tr_b16 v[40:41], v16 offset:0
    ds_read_b64_tr_b16 v[42:43], v16 offset:1024
    ds_read_b64_tr_b16 v[44:45], v17 offset:0
    ds_read_b64_tr_b16 v[46:47], v17 offset:1024
    s_waitcnt lgkmcnt(6)
    v_mfma_f32_32x32x16_bf16 v[64:79], v[48:51], v[56:59], v[64:79]
    v_mfma_f32_32x32x16_bf16 v[80:95], v[48:51], v[60:63], v[80:95]
    v_mfma_f32_32x32x16_bf16 v[96:111], v[52:55], v[56:59], v[96:111]
    v_mfma_f32_32x32x16_bf16 v[112:127], v[52:55], v[60:63], v[112:127]
    ds_read_b128 v[48:51], v9 offset:0
    ds_read_b128 v[52:55], v9 offset:4096
    ds_read_b64_tr_b16 v[56:57], v16 offset:4096
    ds_read_b64_tr_b16 v[58:59], v16 offset:5120
    ds_read_b64_tr_b16 v[60:61], v17 offset:4096
    ds_read_b64_tr_b16 v[62:63], v17 offset:5120
    s_waitcnt lgkmcnt(6)
    v_mfma_f32_32x32x16_bf16 v[64:79], v[32:35], v[40:43], v[64:79]
    v_mfma_f32_32x32x16_bf16 v[80:95], v[32:35], v[44:47], v[80:95]
    v_mfma_f32_32x32x16_bf16 v[96:111], v[36:39], v[40:43], v[96:111]
    v_mfma_f32_32x32x16_bf16 v[112:127], v[36:39], v[44:47], v[112:127]
    ds_read_b128 v[32:35], v10 offset:0
    ds_read_b128 v[36:39], v10 offset:4096
    ds_read_b64_tr_b16 v[40:41], v16 offset:8192
    ds_read_b64_tr_b16 v[42:43], v16 offset:9216
    ds_read_b64_tr_b16 v[44:45], v17 offset:8192
    ds_read_b64_tr_b16 v[46:47], v17 offset:9216
    s_waitcnt lgkmcnt(6)
    v_mfma_f32_32x32x16_bf16 v[64:79], v[48:51], v[56:59], v[64:79]
    v_mfma_f32_32x32x16_bf16 v[80:95], v[48:51], v[60:63], v[80:95]
    v_mfma_f32_32x32x16_bf16 v[96:111], v[52:55], v[56:59], v[96:111]
    v_mfma_f32_32x32x16_bf16 v[112:127], v[52:55], v[60:63], v[112:127]
    ds_read_b128 v[48:51], v11 offset:0
    ds_read_b128 v[52:55], v11 offset:4096
    ds_read_b64_tr_b16 v[56:57], v16 offset:12288
    ds_read_b64_tr_b16 v[58:59], v16 offset:13312
    ds_read_b64_tr_b16 v[60:61], v17 offset:12288
    ds_read_b64_tr_b16 v[62:63], v17 offset:13312
    s_waitcnt lgkmcnt(6)
    v_mfma_f32_32x32x16_bf16 v[64:79], v[32:35], v[40:43], v[64:79]
    v_mfma_f32_32x32x16_bf16 v[80:95], v[32:35], v[44:47], v[80:95]
    v_mfma_f32_32x32x16_bf16 v[96:111], v[36:39], v[40:43], v[96:111]
    v_mfma_f32_32x32x16_bf16 v[112:127], v[36:39], v[44:47], v[112:127]
    s_barrier
    ds_read_b128 v[32:35], v8 offset:32768
    ds_read_b128 v[36:39], v8 offset:36864
    ds_read_b64_tr_b16 v[40:41], v16 offset:32768
    ds_read_b64_tr_b16 v[42:43], v16 offset:33792
    ds_read_b64_tr_b16 v[44:45], v17 offset:32768
    ds_read_b64_tr_b16 v[46:47], v17 offset:33792
    s_waitcnt lgkmcnt(6)
    v_mfma_f32_32x32x16_bf16 v[64:79], v[48:51], v[56:59], v[64:79]
    v_mfma_f32_32x32x16_bf16 v[80:95], v[48:51], v[60:63], v[80:95]
    v_mfma_f32_32x32x16_bf16 v[96:111], v[52:55], v[56:59], v[96:111]
    v_mfma_f32_32x32x16_bf16 v[112:127], v[52:55], v[60:63], v[112:127]
    ds_read_b128 v[48:51], v9 offset:32768
    ds_read_b128 v[52:55], v9 offset:36864
    ds_read_b64_tr_b16 v[56:57], v16 offset:36864
    ds_read_b64_tr_b16 v[58:59], v16 offset:37888
    ds_read_b64_tr_b16 v[60:61], v17 offset:36864
    ds_read_b64_tr_b16 v[62:63], v17 offset:37888
    s_waitcnt lgkmcnt(6)
    v_mfma_f32_32x32x16_bf16 v[64:79], v[32:35], v[40:43], v[64:79]
    v_mfma_f32_32x32x16_bf16 v[80:95], v[32:35], v[44:47], v[80:95]
    v_mfma_f32_32x32x16_bf16 v[96:111], v[36:39], v[40:43], v[96:111]
    v_mfma_f32_32x32x16_bf16 v[112:127], v[36:39], v[44:47], v[112:127]
    ds_read_b128 v[32:35], v10 offset:32768
    ds_read_b128 v[36:39], v10 offset:36864
    ds_read_b64_tr_b16 v[40:41], v16 offset:40960
    ds_read_b64_tr_b16 v[42:43], v16 offset:41984
    ds_read_b64_tr_b16 v[44:45], v17 offset:40960
    ds_read_b64_tr_b16 v[46:47], v17 offset:41984
    s_waitcnt lgkmcnt(6)
    v_mfma_f32_32x32x16_bf16 v[64:79], v[48:51], v[56:59], v[64:79]
    v_mfma_f32_32x32x16_bf16 v[80:95], v[48:51], v[60:63], v[80:95]
    v_mfma_f32_32x32x16_bf16 v[96:111], v[52:55], v[56:59], v[96:111]
    v_mfma_f32_32x32x16_bf16 v[112:127], v[52:55], v[60:63], v[112:127]
    ds_read_b128 v[48:51], v11 offset:32768
    ds_read_b128 v[52:55], v11 offset:36864
    ds_read_b64_tr_b16 v[56:57], v16 offset:45056
    ds_read_b64_tr_b16 v[58:59], v16 offset:46080
    ds_read_b64_tr_b16 v[60:61], v17 offset:45056
    ds_read_b64_tr_b16 v[62:63], v17 offset:46080
    s_waitcnt lgkmcnt(6)
    v_mfma_f32_32x32x16_bf16 v[64:79], v[32:35], v[40:43], v[64:79]
    v_mfma_f32_32x32x16_bf16 v[80:95], v[32:35], v[44:47], v[80:95]
    v_mfma_f32_32x32x16_bf16 v[96:111], v[36:39], v[40:43], v[96:111]
    v_mfma_f32_32x32x16_bf16 v[112:127], v[36:39], v[44:47], v[112:127]
    s_waitcnt lgkmcnt(0)
    v_mfma_f32_32x32x16_bf16 v[64:79], v[48:51], v[56:59], v[64:79]
    v_mfma_f32_32x32x16_bf16 v[80:95], v[48:51], v[60:63], v[80:95]
    v_mfma_f32_32x32x16_bf16 v[96:111], v[52:55], v[56:59], v[96:111]
    v_mfma_f32_32x32x16_bf16 v[112:127], v[52:55], v[60:63], v[112:127]
    s_barrier
    ds_read_b32 v8, v202
    ds_read_b32 v10, v202 offset:128
    ds_read_b128 v[128:131], v201 offset:0
    ds_read_b128 v[144:147], v201 offset:512
    ds_read_b128 v[132:135], v201 offset:32
    ds_read_b128 v[148:151], v201 offset:544
    ds_read_b128 v[136:139], v201 offset:64
    ds_read_b128 v[152:155], v201 offset:576
    ds_read_b128 v[140:143], v201 offset:96
    ds_read_b128 v[156:159], v201 offset:608
    ds_read_b128 v[160:163], v201 offset:128
    ds_read_b128 v[176:179], v201 offset:640
    ds_read_b128 v[164:167], v201 offset:160
    ds_read_b128 v[180:183], v201 offset:672
    s_waitcnt lgkmcnt(4)
    ds_read_b128 v[168:171], v201 offset:192
    ds_read_b128 v[184:187], v201 offset:704
    ds_read_b128 v[172:175], v201 offset:224
    ds_read_b128 v[188:191], v201 offset:736
    v_pk_mul_f32 v[48:49], v[144:145], v[8:9] op_sel_hi:[1,0]
    v_pk_fma_f32 v[64:65], v[64:65], v[128:129], v[48:49]
    v_pk_mul_f32 v[50:51], v[146:147], v[8:9] op_sel_hi:[1,0]
    v_pk_fma_f32 v[66:67], v[66:67], v[130:131], v[50:51]
    v_pk_mul_f32 v[48:49], v[148:149], v[8:9] op_sel_hi:[1,0]
    v_pk_fma_f32 v[68:69], v[68:69], v[132:133], v[48:49]
    v_pk_mul_f32 v[50:51], v[150:151], v[8:9] op_sel_hi:[1,0]
    v_pk_fma_f32 v[70:71], v[70:71], v[134:135], v[50:51]
    v_cvt_pk_bf16_f32 v32, v64, v65
    v_cvt_pk_bf16_f32 v33, v66, v67
    v_cvt_pk_bf16_f32 v34, v68, v69
    v_cvt_pk_bf16_f32 v35, v70, v71
    s_add_u32 s29, s59, 0
    buffer_store_dwordx4 v[32:35], v200, s[32:35], s29 offen sc1
    v_pk_mul_f32 v[48:49], v[152:153], v[8:9] op_sel_hi:[1,0]
    v_pk_fma_f32 v[72:73], v[72:73], v[136:137], v[48:49]
    v_pk_mul_f32 v[50:51], v[154:155], v[8:9] op_sel_hi:[1,0]
    v_pk_fma_f32 v[74:75], v[74:75], v[138:139], v[50:51]
    v_pk_mul_f32 v[48:49], v[156:157], v[8:9] op_sel_hi:[1,0]
    v_pk_fma_f32 v[76:77], v[76:77], v[140:141], v[48:49]
    v_pk_mul_f32 v[50:51], v[158:159], v[8:9] op_sel_hi:[1,0]
    v_pk_fma_f32 v[78:79], v[78:79], v[142:143], v[50:51]
    v_cvt_pk_bf16_f32 v36, v72, v73
    v_cvt_pk_bf16_f32 v37, v74, v75
    v_cvt_pk_bf16_f32 v38, v76, v77
    v_cvt_pk_bf16_f32 v39, v78, v79
    s_add_u32 s29, s59, 20608
    buffer_store_dwordx4 v[36:39], v200, s[32:35], s29 offen sc1
    v_pk_mul_f32 v[48:49], v[144:145], v[10:11] op_sel_hi:[1,0]
    v_pk_fma_f32 v[80:81], v[80:81], v[128:129], v[48:49]
    v_pk_mul_f32 v[50:51], v[146:147], v[10:11] op_sel_hi:[1,0]
    v_pk_fma_f32 v[82:83], v[82:83], v[130:131], v[50:51]
    v_pk_mul_f32 v[48:49], v[148:149], v[10:11] op_sel_hi:[1,0]
    v_pk_fma_f32 v[84:85], v[84:85], v[132:133], v[48:49]
    v_pk_mul_f32 v[50:51], v[150:151], v[10:11] op_sel_hi:[1,0]
    v_pk_fma_f32 v[86:87], v[86:87], v[134:135], v[50:51]
    v_cvt_pk_bf16_f32 v40, v80, v81
    v_cvt_pk_bf16_f32 v41, v82, v83
    v_cvt_pk_bf16_f32 v42, v84, v85
    v_cvt_pk_bf16_f32 v43, v86, v87
    s_add_u32 s29, s59, 1024
    buffer_store_dwordx4 v[40:43], v200, s[32:35], s29 offen sc1
    v_pk_mul_f32 v[48:49], v[152:153], v[10:11] op_sel_hi:[1,0]
    v_pk_fma_f32 v[88:89], v[88:89], v[136:137], v[48:49]
    v_pk_mul_f32 v[50:51], v[154:155], v[10:11] op_sel_hi:[1,0]
    v_pk_fma_f32 v[90:91], v[90:91], v[138:139], v[50:51]
    v_pk_mul_f32 v[48:49], v[156:157], v[10:11] op_sel_hi:[1,0]
    v_pk_fma_f32 v[92:93], v[92:93], v[140:141], v[48:49]
    v_pk_mul_f32 v[50:51], v[158:159], v[10:11] op_sel_hi:[1,0]
    v_pk_fma_f32 v[94:95], v[94:95], v[142:143], v[50:51]
    v_cvt_pk_bf16_f32 v44, v88, v89
    v_cvt_pk_bf16_f32 v45, v90, v91
    v_cvt_pk_bf16_f32 v46, v92, v93
    v_cvt_pk_bf16_f32 v47, v94, v95
    s_add_u32 s29, s59, 21632
    buffer_store_dwordx4 v[44:47], v200, s[32:35], s29 offen sc1
    s_waitcnt lgkmcnt(0)
    v_pk_mul_f32 v[48:49], v[176:177], v[8:9] op_sel_hi:[1,0]
    v_pk_fma_f32 v[96:97], v[96:97], v[160:161], v[48:49]
    v_pk_mul_f32 v[50:51], v[178:179], v[8:9] op_sel_hi:[1,0]
    v_pk_fma_f32 v[98:99], v[98:99], v[162:163], v[50:51]
    v_pk_mul_f32 v[48:49], v[180:181], v[8:9] op_sel_hi:[1,0]
    v_pk_fma_f32 v[100:101], v[100:101], v[164:165], v[48:49]
    v_pk_mul_f32 v[50:51], v[182:183], v[8:9] op_sel_hi:[1,0]
    v_pk_fma_f32 v[102:103], v[102:103], v[166:167], v[50:51]
    v_cvt_pk_bf16_f32 v32, v96, v97
    v_cvt_pk_bf16_f32 v33, v98, v99
    v_cvt_pk_bf16_f32 v34, v100, v101
    v_cvt_pk_bf16_f32 v35, v102, v103
    s_add_u32 s29, s59, 41216
    buffer_store_dwordx4 v[32:35], v200, s[32:35], s29 offen sc1
    v_pk_mul_f32 v[48:49], v[184:185], v[8:9] op_sel_hi:[1,0]
    v_pk_fma_f32 v[104:105], v[104:105], v[168:169], v[48:49]
    v_pk_mul_f32 v[50:51], v[186:187], v[8:9] op_sel_hi:[1,0]
    v_pk_fma_f32 v[106:107], v[106:107], v[170:171], v[50:51]
    v_pk_mul_f32 v[48:49], v[188:189], v[8:9] op_sel_hi:[1,0]
    v_pk_fma_f32 v[108:109], v[108:109], v[172:173], v[48:49]
    v_pk_mul_f32 v[50:51], v[190:191], v[8:9] op_sel_hi:[1,0]
    v_pk_fma_f32 v[110:111], v[110:111], v[174:175], v[50:51]
    v_cvt_pk_bf16_f32 v36, v104, v105
    v_cvt_pk_bf16_f32 v37, v106, v107
    v_cvt_pk_bf16_f32 v38, v108, v109
    v_cvt_pk_bf16_f32 v39, v110, v111
    s_add_u32 s29, s59, 61824
    buffer_store_dwordx4 v[36:39], v200, s[32:35], s29 offen sc1
    v_pk_mul_f32 v[48:49], v[176:177], v[10:11] op_sel_hi:[1,0]
    v_pk_fma_f32 v[112:113], v[112:113], v[160:161], v[48:49]
    v_pk_mul_f32 v[50:51], v[178:179], v[10:11] op_sel_hi:[1,0]
    v_pk_fma_f32 v[114:115], v[114:115], v[162:163], v[50:51]
    v_pk_mul_f32 v[48:49], v[180:181], v[10:11] op_sel_hi:[1,0]
    v_pk_fma_f32 v[116:117], v[116:117], v[164:165], v[48:49]
    v_pk_mul_f32 v[50:51], v[182:183], v[10:11] op_sel_hi:[1,0]
    v_pk_fma_f32 v[118:119], v[118:119], v[166:167], v[50:51]
    v_cvt_pk_bf16_f32 v40, v112, v113
    v_cvt_pk_bf16_f32 v41, v114, v115
    v_cvt_pk_bf16_f32 v42, v116, v117
    v_cvt_pk_bf16_f32 v43, v118, v119
    s_add_u32 s29, s59, 42240
    buffer_store_dwordx4 v[40:43], v200, s[32:35], s29 offen sc1
    v_pk_mul_f32 v[48:49], v[184:185], v[10:11] op_sel_hi:[1,0]
    v_pk_fma_f32 v[120:121], v[120:121], v[168:169], v[48:49]
    v_pk_mul_f32 v[50:51], v[186:187], v[10:11] op_sel_hi:[1,0]
    v_pk_fma_f32 v[122:123], v[122:123], v[170:171], v[50:51]
    v_pk_mul_f32 v[48:49], v[188:189], v[10:11] op_sel_hi:[1,0]
    v_pk_fma_f32 v[124:125], v[124:125], v[172:173], v[48:49]
    v_pk_mul_f32 v[50:51], v[190:191], v[10:11] op_sel_hi:[1,0]
    v_pk_fma_f32 v[126:127], v[126:127], v[174:175], v[50:51]
    v_cvt_pk_bf16_f32 v44, v120, v121
    v_cvt_pk_bf16_f32 v45, v122, v123
    v_cvt_pk_bf16_f32 v46, v124, v125
    v_cvt_pk_bf16_f32 v47, v126, v127
    s_add_u32 s29, s59, 62848
    buffer_store_dwordx4 v[44:47], v200, s[32:35], s29 offen sc1
    s_cmp_lg_u32 s58, 0
    s_cbranch_scc1 L_p1_noones
    v_mov_b32 v8, 1065369472
    v_mov_b32 v9, 1065369472
    v_mov_b32 v10, 1065369472
    v_mov_b32 v11, 1065369472
    v_and_b32 v5, 1, v255
    v_lshlrev_b32 v5, 4, v5
    v_bfe_u32 v6, v255, 1, 2
    v_mul_u32_u24 v6, 20608, v6
    v_add_u32 v5, v5, v6
    v_add_u32 v5, 20480, v5
    v_cmp_gt_u32 vcc, 8, v255
    s_and_saveexec_b64 s[30:31], vcc
    buffer_store_dwordx4 v[8:11], v5, s[32:35], s59 offen sc1
    s_mov_b64 exec, s[30:31]
L_p1_noones:
L_p1_stored:
    v_mov_b32 v6, v255
    s_and_b32 s29, s2, 7
    s_lshr_b32 s30, s2, 3
    s_and_b32 s57, s30, 7
    s_lshr_b32 s30, s30, 3
    s_lshl_b32 s29, s29, 2
    s_add_u32 s56, s29, s30
    v_lshlrev_b32 v1, 4, v6
    v_and_b32 v7, 31, v6
    v_lshrrev_b32 v0, 5, v6
    s_and_b32 s62, s56, 1
    s_mul_i32 s63, s56, 5
    s_lshr_b32 s63, s63, 1
    v_add_u32 v2, s62, v0
    v_lshlrev_b32 v2, 15, v2
    v_lshl_add_u32 v2, v7, 4, v2
    s_xor_b32 s29, s62, 1
    s_lshl_b32 s29, s29, 16
    s_lshl_b32 s30, s62, 3
    s_add_u32 s29, s29, s30
    v_lshlrev_b32 v3, 4, v7
    v_add_u32 v3, s29, v3
    v_lshl_add_u32 v28, v0, 9, v3
    s_mul_i32 s29, s56, 20
    v_add_u32 v4, s29, v7
    v_mov_b32 v8, 640
    v_cmp_eq_u32 vcc, 20, v7
    v_mov_b32 v9, 268435456
    v_cmp_eq_u32 s[30:31], 0, v0
    v_cndmask_b32 v4, v4, v8, vcc
    v_lshlrev_b32 v4, 5, v4
    v_lshl_add_u32 v4, v0, 4, v4
    v_cmp_gt_u32 vcc, 21, v7
    v_lshlrev_b32 v7, 3, v7
    v_cndmask_b32 v7, v9, v7, s[30:31]
    v_cndmask_b32 v4, v9, v4, vcc
    v_add_u32 v5, 20608, v4
    s_and_b32 s29, s3, 1
    s_lshl_b32 s29, s29, 2
    s_lshl_b32 s61, s57, 3
    s_add_u32 s61, s61, s29
    s_lshl_b32 s63, s63, 15
    s_add_u32 s36, s24, 0x280200
    s_addc_u32 s37, s25, 0
    s_mov_b32 s38, 0x280000
    s_mov_b32 s39, 0x00020000
    s_add_u32 s40, s24, 0x500300
    s_addc_u32 s41, s25, 0
    s_mov_b32 s42, 0x284000
    s_mov_b32 s43, 0x00020000
    s_add_u32 s32, s24, 0x100
    s_addc_u32 s33, s25, 0
    s_mov_b32 s34, 0x280000
    s_mov_b32 s35, 0x00020000
    s_add_u32 s44, s24, 0x784400
    s_addc_u32 s45, s25, 0
    s_mov_b32 s46, 0x200000
    s_mov_b32 s47, 0x00020000
    s_add_u32 s48, s24, 0x984500
    s_addc_u32 s49, s25, 0
    s_mov_b32 s50, 0x80000
    s_mov_b32 s51, 0x00020000
    s_lshl_b32 s64, s61, 9
    s_add_u32 s64, s64, s63
    s_lshr_b32 s29, s3, 1
    s_lshl_b32 s58, s29, 14
    s_add_u32 s58, s58, s63
    s_mul_i32 s60, s29, 1318912
    v_mov_b32 v40, 0
    v_mov_b32 v41, 0
    v_mov_b32 v42, 0
    v_mov_b32 v43, 0
    v_mov_b32 v44, 0
    v_mov_b32 v45, 0
    v_mov_b32 v46, 0
    v_mov_b32 v47, 0
    v_mov_b32 v48, 0
    v_mov_b32 v49, 0
    v_mov_b32 v50, 0
    v_mov_b32 v51, 0
    v_mov_b32 v52, 0
    v_mov_b32 v53, 0
    v_mov_b32 v54, 0
    v_mov_b32 v55, 0
    v_mov_b32 v56, 0
    v_mov_b32 v57, 0
    v_mov_b32 v58, 0
    v_mov_b32 v59, 0
    v_mov_b32 v60, 0
    v_mov_b32 v61, 0
    v_mov_b32 v62, 0
    v_mov_b32 v63, 0
    v_mov_b32 v64, 0
    v_mov_b32 v65, 0
    v_mov_b32 v66, 0
    v_mov_b32 v67, 0
    v_mov_b32 v68, 0
    v_mov_b32 v69, 0
    v_mov_b32 v70, 0
    v_mov_b32 v71, 0
    v_mov_b32 v72, 0
    v_mov_b32 v73, 0
    v_mov_b32 v74, 0
    v_mov_b32 v75, 0
    v_mov_b32 v76, 0
    v_mov_b32 v77, 0
    v_mov_b32 v78, 0
    v_mov_b32 v79, 0
    v_mov_b32 v80, 0
    v_mov_b32 v81, 0
    v_mov_b32 v82, 0
    v_mov_b32 v83, 0
    v_mov_b32 v84, 0
    v_mov_b32 v85, 0
    v_mov_b32 v86, 0
    v_mov_b32 v87, 0
    v_mov_b32 v88, 0
    v_mov_b32 v89, 0
    v_mov_b32 v90, 0
    v_mov_b32 v91, 0
    v_mov_b32 v92, 0
    v_mov_b32 v93, 0
    v_mov_b32 v94, 0
    v_mov_b32 v95, 0
    v_mov_b32 v96, 0
    v_mov_b32 v97, 0
    v_mov_b32 v98, 0
    v_mov_b32 v99, 0
    v_mov_b32 v100, 0
    v_mov_b32 v101, 0
    v_mov_b32 v102, 0
    v_mov_b32 v103, 0
    v_mov_b32 v168, 0
    v_mov_b32 v169, 0
    v_mov_b32 v170, 0
    v_mov_b32 v171, 0
    v_mov_b32 v172, 0
    v_mov_b32 v173, 0
    v_mov_b32 v174, 0
    v_mov_b32 v175, 0
    v_mov_b32 v176, 0
    v_mov_b32 v177, 0
    v_mov_b32 v178, 0
    v_mov_b32 v179, 0
    v_mov_b32 v180, 0
    v_mov_b32 v181, 0
    v_mov_b32 v182, 0
    v_mov_b32 v183, 0
    v_mov_b32 v230, 0
    v_mov_b32 v231, 0
    v_mov_b32 v232, 0
    v_mov_b32 v233, 0
    v_mov_b32 v234, 0
    v_mov_b32 v235, 0
    v_mov_b32 v236, 0
    v_mov_b32 v237, 0
    s_mov_b32 s59, 8
    s_mul_i32 s29, s56, 20
    s_lshr_b32 s30, s29, 7
    s_add_u32 s29, s29, 19
    s_lshr_b32 s31, s29, 7
    v_bfe_u32 v8, v255, 3, 1
    v_mov_b32 v9, s30
    v_mov_b32 v10, s31
    v_cmp_eq_u32 vcc, 0, v8
    s_lshr_b32 s29, s3, 1
    s_lshl_b32 s29, s29, 3
    v_cndmask_b32 v9, v10, v9, vcc
    v_bfe_u32 v10, v255, 4, 1
    v_mul_u32_u24 v10, 5, v10
    v_add_u32 v10, v10, v9
    v_add_u32 v10, 5, v10
    v_and_b32 v11, 7, v255
    v_add_u32 v11, s29, v11
    v_lshl_add_u32 v10, v10, 4, v11
    s_lshr_b32 s30, s61, 2
    v_lshl_add_u32 v11, v9, 4, s30
    v_cmp_gt_u32 vcc, 32, v255
    s_nop 1
    v_cndmask_b32 v10, v11, v10, vcc
    v_lshlrev_b32 v240, 7, v10
    s_lshl_b32 s30, s28, 4
    s_add_u32 s70, s30, s27
    s_add_u32 s52, s24, 0xa60800
    s_addc_u32 s53, s25, 0
    s_mov_b32 s54, 0x8000
    s_mov_b32 s55, 0x00020000
    s_lshl_b32 s29, s70, 7
    v_mov_b32 v14, s29
    v_mov_b32 v15, s26
    v_mov_b32 v10, 163332
    v_mov_b32 v11, 1
    s_waitcnt vmcnt(0)
    s_mov_b64 exec, 1
    ds_add_rtn_u32 v12, v10, v11
    s_mov_b64 exec, -1
    s_waitcnt lgkmcnt(0)
    v_readfirstlane_b32 s29, v12
    s_cmp_lg_u32 s29, 3
    s_cbranch_scc1 L_p1_done
    s_mov_b64 exec, 1
    buffer_store_dword v15, v14, s[52:55], 0 offen sc1
    s_mov_b64 exec, -1
    s_branch L_p1_done
L_p1_idle:
    v_mov_b32 v220, 0
    v_mov_b32 v221, 0
    v_mov_b32 v222, 0
    v_mov_b32 v223, 0
    s_mov_b32 s30, 1065369472
    s_waitcnt vmcnt(10)
    v_dot2_f32_bf16 v220, v190, s30, v220
    v_dot2_f32_bf16 v221, v190, v190, v221
    v_dot2_f32_bf16 v222, v190, v200, v222
    v_dot2_f32_bf16 v223, v200, s30, v223
    v_dot2_f32_bf16 v220, v191, s30, v220
    v_dot2_f32_bf16 v221, v191, v191, v221
    v_dot2_f32_bf16 v222, v191, v201, v222
    v_dot2_f32_bf16 v223, v201, s30, v223
    v_dot2_f32_bf16 v220, v192, s30, v220
    v_dot2_f32_bf16 v221, v192, v192, v221
    v_dot2_f32_bf16 v222, v192, v202, v222
    v_dot2_f32_bf16 v223, v202, s30, v223
    v_dot2_f32_bf16 v220, v193, s30, v220
    v_dot2_f32_bf16 v221, v193, v193, v221
    v_dot2_f32_bf16 v222, v193, v203, v222
    v_dot2_f32_bf16 v223, v203, s30, v223
    v_dot2_f32_bf16 v220, v194, s30, v220
    v_dot2_f32_bf16 v221, v194, v194, v221
    v_dot2_f32_bf16 v222, v194, v204, v222
    v_dot2_f32_bf16 v223, v204, s30, v223
    v_dot2_f32_bf16 v220, v195, s30, v220
    v_dot2_f32_bf16 v221, v195, v195, v221
    v_dot2_f32_bf16 v222, v195, v205, v222
    v_dot2_f32_bf16 v223, v205, s30, v223
    v_dot2_f32_bf16 v220, v196, s30, v220
    v_dot2_f32_bf16 v221, v196, v196, v221
    v_dot2_f32_bf16 v222, v196, v206, v222
    v_dot2_f32_bf16 v223, v206, s30, v223
    v_dot2_f32_bf16 v220, v197, s30, v220
    v_dot2_f32_bf16 v221, v197, v197, v221
    v_dot2_f32_bf16 v222, v197, v207, v222
    v_dot2_f32_bf16 v223, v207, s30, v223
    v_dot2_f32_bf16 v220, v198, s30, v220
    v_dot2_f32_bf16 v221, v198, v198, v221
    v_dot2_f32_bf16 v222, v198, v208, v222
    v_dot2_f32_bf16 v223, v208, s30, v223
    v_dot2_f32_bf16 v220, v199, s30, v220
    v_dot2_f32_bf16 v221, v199, v199, v221
    v_dot2_f32_bf16 v222, v199, v209, v222
    v_dot2_f32_bf16 v223, v209, s30, v223
    s_nop 3
    v_add_f32_dpp v220, v220, v220 row_shr:1 row_mask:0xf bank_mask:0xf
    v_add_f32_dpp v221, v221, v221 row_shr:1 row_mask:0xf bank_mask:0xf
    v_add_f32_dpp v222, v222, v222 row_shr:1 row_mask:0xf bank_mask:0xf
    v_add_f32_dpp v223, v223, v223 row_shr:1 row_mask:0xf bank_mask:0xf
    v_add_f32_dpp v220, v220, v220 row_shr:2 row_mask:0xf bank_mask:0xf
    v_add_f32_dpp v221, v221, v221 row_shr:2 row_mask:0xf bank_mask:0xf
    v_add_f32_dpp v222, v222, v222 row_shr:2 row_mask:0xf bank_mask:0xf
    v_add_f32_dpp v223, v223, v223 row_shr:2 row_mask:0xf bank_mask:0xf
    v_add_f32_dpp v220, v220, v220 row_shr:4 row_mask:0xf bank_mask:0xf
    v_add_f32_dpp v221, v221, v221 row_shr:4 row_mask:0xf bank_mask:0xf
    v_add_f32_dpp v222, v222, v222 row_shr:4 row_mask:0xf bank_mask:0xf
    v_add_f32_dpp v223, v223, v223 row_shr:4 row_mask:0xf bank_mask:0xf
    v_add_f32_dpp v220, v220, v220 row_shr:8 row_mask:0xf bank_mask:0xf
    v_add_f32_dpp v221, v221, v221 row_shr:8 row_mask:0xf bank_mask:0xf
    v_add_f32_dpp v222, v222, v222 row_shr:8 row_mask:0xf bank_mask:0xf
    v_add_f32_dpp v223, v223, v223 row_shr:8 row_mask:0xf bank_mask:0xf
    v_add_f32_dpp v220, v220, v220 row_bcast:15 row_mask:0xa bank_mask:0xf
    v_add_f32_dpp v221, v221, v221 row_bcast:15 row_mask:0xa bank_mask:0xf
    v_add_f32_dpp v222, v222, v222 row_bcast:15 row_mask:0xa bank_mask:0xf
    v_add_f32_dpp v223, v223, v223 row_bcast:15 row_mask:0xa bank_mask:0xf
    s_mov_b32 s30, 0x3acccccd
    v_mul_f32 v160, s30, v220
    v_mul_f32 v221, s30, v221
    v_fma_f32 v221, -v160, v160, v221
    v_max_f32 v221, 0, v221
    v_add_f32 v221, 0x3727c5ac, v221
    v_rsq_f32 v161, v221
    v_fma_f32 v222, -v160, v223, v222
    s_nop 0
    v_mul_f32 v162, v222, v161
    v_ashrrev_i32 v220, 31, v162
    v_or_b32 v220, 0x80000000, v220
    v_xor_b32 v220, v220, v162
    v_and_b32 v220, 0xfffff800, v220
    v_or_b32 v163, v220, v164
    s_waitcnt vmcnt(0)
    v_mov_b32 v170, 0
    s_mov_b32 s67, 200000
L_idle_nonce:
    buffer_load_dword v171, v170, s[52:55], 0 offen sc1
    s_waitcnt vmcnt(0)
    v_readfirstlane_b32 s26, v171
    s_cmp_lg_u32 s26, 0
    s_cbranch_scc1 L_idle_nonce_ok
    s_sleep 2
    s_sub_u32 s67, s67, 1
    s_cmp_lg_u32 s67, 0
    s_cbranch_scc1 L_idle_nonce
L_idle_nonce_ok:
    v_mov_b32 v170, 163328
    v_mov_b32 v171, s26
    ds_write_b32 v170, v171
    s_add_u32 s32, s24, 0xa04600
    s_addc_u32 s33, s25, 0
    s_mov_b32 s34, 0x8000
    s_mov_b32 s35, 0x00020000
    s_add_u32 s36, s24, 0xa50800
    s_addc_u32 s37, s25, 0
    s_mov_b32 s38, 0x8000
    s_mov_b32 s39, 0x00020000
    v_mov_b32 v172, v160
    v_mov_b32 v173, s26
    v_mov_b32 v174, v161
    v_mov_b32 v175, s26
    v_lshlrev_b32 v176, 3, v164
    v_lshlrev_b32 v177, 2, v164
    v_lshlrev_b32 v178, 4, v164
    s_mov_b32 s29, 16384
    s_mov_b32 s30, 24576
    v_and_b32 v179, 31, v255
    v_cmp_eq_u32 vcc, 31, v179
    s_and_saveexec_b64 s[56:57], vcc
    buffer_store_dwordx4 v[172:175], v178, s[36:39], 0 offen sc1
    buffer_store_dwordx2 v[160:161], v176, s[32:35], 0 offen sc1
    buffer_store_dword v162, v177, s[32:35], s29 offen sc1
    buffer_store_dword v163, v177, s[32:35], s30 offen sc1
    s_mov_b64 exec, s[56:57]
    s_waitcnt vmcnt(0) lgkmcnt(0)
    s_barrier
    s_cmp_lg_u32 s3, 0
    s_cbranch_scc1 L_p1_done0
    s_add_u32 s52, s24, 0xa58800
    s_addc_u32 s53, s25, 0
    s_mov_b32 s54, 0x8000
    s_mov_b32 s55, 0x00020000
    s_lshl_b32 s29, s2, 7
    v_mov_b32 v10, s29
    v_mov_b32 v11, s26
    s_mov_b64 s[30:31], exec
    s_mov_b64 exec, 1
    buffer_store_dword v11, v10, s[52:55], 0 offen sc1
    s_mov_b64 exec, s[30:31]
L_p1_done0:
    v_mov_b32 v6, v255
    s_and_b32 s29, s2, 7
    s_lshr_b32 s30, s2, 3
    s_and_b32 s57, s30, 7
    s_lshr_b32 s30, s30, 3
    s_lshl_b32 s29, s29, 2
    s_add_u32 s56, s29, s30
    v_lshlrev_b32 v1, 4, v6
    v_and_b32 v7, 31, v6
    v_lshrrev_b32 v0, 5, v6
    s_and_b32 s62, s56, 1
    s_mul_i32 s63, s56, 5
    s_lshr_b32 s63, s63, 1
    v_add_u32 v2, s62, v0
    v_lshlrev_b32 v2, 15, v2
    v_lshl_add_u32 v2, v7, 4, v2
    s_xor_b32 s29, s62, 1
    s_lshl_b32 s29, s29, 16
    s_lshl_b32 s30, s62, 3
    s_add_u32 s29, s29, s30
    v_lshlrev_b32 v3, 4, v7
    v_add_u32 v3, s29, v3
    v_lshl_add_u32 v28, v0, 9, v3
    s_mul_i32 s29, s56, 20
    v_add_u32 v4, s29, v7
    v_mov_b32 v8, 640
    v_cmp_eq_u32 vcc, 20, v7
    v_mov_b32 v9, 268435456
    v_cmp_eq_u32 s[30:31], 0, v0
    v_cndmask_b32 v4, v4, v8, vcc
    v_lshlrev_b32 v4, 5, v4
    v_lshl_add_u32 v4, v0, 4, v4
    v_cmp_gt_u32 vcc, 21, v7
    v_lshlrev_b32 v7, 3, v7
    v_cndmask_b32 v7, v9, v7, s[30:31]
    v_cndmask_b32 v4, v9, v4, vcc
    v_add_u32 v5, 20608, v4
    s_and_b32 s29, s3, 1
    s_lshl_b32 s29, s29, 2
    s_lshl_b32 s61, s57, 3
    s_add_u32 s61, s61, s29
    s_lshl_b32 s63, s63, 15
    s_add_u32 s36, s24, 0x280200
    s_addc_u32 s37, s25, 0
    s_mov_b32 s38, 0x280000
    s_mov_b32 s39, 0x00020000
    s_add_u32 s40, s24, 0x500300
    s_addc_u32 s41, s25, 0
    s_mov_b32 s42, 0x284000
    s_mov_b32 s43, 0x00020000
    s_add_u32 s32, s24, 0x100
    s_addc_u32 s33, s25, 0
    s_mov_b32 s34, 0x280000
    s_mov_b32 s35, 0x00020000
    s_add_u32 s44, s24, 0x784400
    s_addc_u32 s45, s25, 0
    s_mov_b32 s46, 0x200000
    s_mov_b32 s47, 0x00020000
    s_add_u32 s48, s24, 0x984500
    s_addc_u32 s49, s25, 0
    s_mov_b32 s50, 0x80000
    s_mov_b32 s51, 0x00020000
    s_lshl_b32 s64, s61, 9
    s_add_u32 s64, s64, s63
    s_lshr_b32 s29, s3, 1
    s_lshl_b32 s58, s29, 14
    s_add_u32 s58, s58, s63
    s_mul_i32 s60, s29, 1318912
    v_mov_b32 v40, 0
    v_mov_b32 v41, 0
    v_mov_b32 v42, 0
    v_mov_b32 v43, 0
    v_mov_b32 v44, 0
    v_mov_b32 v45, 0
    v_mov_b32 v46, 0
    v_mov_b32 v47, 0
    v_mov_b32 v48, 0
    v_mov_b32 v49, 0
    v_mov_b32 v50, 0
    v_mov_b32 v51, 0
    v_mov_b32 v52, 0
    v_mov_b32 v53, 0
    v_mov_b32 v54, 0
    v_mov_b32 v55, 0
    v_mov_b32 v56, 0
    v_mov_b32 v57, 0
    v_mov_b32 v58, 0
    v_mov_b32 v59, 0
    v_mov_b32 v60, 0
    v_mov_b32 v61, 0
    v_mov_b32 v62, 0
    v_mov_b32 v63, 0
    v_mov_b32 v64, 0
    v_mov_b32 v65, 0
    v_mov_b32 v66, 0
    v_mov_b32 v67, 0
    v_mov_b32 v68, 0
    v_mov_b32 v69, 0
    v_mov_b32 v70, 0
    v_mov_b32 v71, 0
    v_mov_b32 v72, 0
    v_mov_b32 v73, 0
    v_mov_b32 v74, 0
    v_mov_b32 v75, 0
    v_mov_b32 v76, 0
    v_mov_b32 v77, 0
    v_mov_b32 v78, 0
    v_mov_b32 v79, 0
    v_mov_b32 v80, 0
    v_mov_b32 v81, 0
    v_mov_b32 v82, 0
    v_mov_b32 v83, 0
    v_mov_b32 v84, 0
    v_mov_b32 v85, 0
    v_mov_b32 v86, 0
    v_mov_b32 v87, 0
    v_mov_b32 v88, 0
    v_mov_b32 v89, 0
    v_mov_b32 v90, 0
    v_mov_b32 v91, 0
    v_mov_b32 v92, 0
    v_mov_b32 v93, 0
    v_mov_b32 v94, 0
    v_mov_b32 v95, 0
    v_mov_b32 v96, 0
    v_mov_b32 v97, 0
    v_mov_b32 v98, 0
    v_mov_b32 v99, 0
    v_mov_b32 v100, 0
    v_mov_b32 v101, 0
    v_mov_b32 v102, 0
    v_mov_b32 v103, 0
    v_mov_b32 v168, 0
    v_mov_b32 v169, 0
    v_mov_b32 v170, 0
    v_mov_b32 v171, 0
    v_mov_b32 v172, 0
    v_mov_b32 v173, 0
    v_mov_b32 v174, 0
    v_mov_b32 v175, 0
    v_mov_b32 v176, 0
    v_mov_b32 v177, 0
    v_mov_b32 v178, 0
    v_mov_b32 v179, 0
    v_mov_b32 v180, 0
    v_mov_b32 v181, 0
    v_mov_b32 v182, 0
    v_mov_b32 v183, 0
    v_mov_b32 v230, 0
    v_mov_b32 v231, 0
    v_mov_b32 v232, 0
    v_mov_b32 v233, 0
    v_mov_b32 v234, 0
    v_mov_b32 v235, 0
    v_mov_b32 v236, 0
    v_mov_b32 v237, 0
    s_mov_b32 s59, 8
    s_mul_i32 s29, s56, 20
    s_lshr_b32 s30, s29, 7
    s_add_u32 s29, s29, 19
    s_lshr_b32 s31, s29, 7
    v_bfe_u32 v8, v255, 3, 1
    v_mov_b32 v9, s30
    v_mov_b32 v10, s31
    v_cmp_eq_u32 vcc, 0, v8
    s_lshr_b32 s29, s3, 1
    s_lshl_b32 s29, s29, 3
    v_cndmask_b32 v9, v10, v9, vcc
    v_bfe_u32 v10, v255, 4, 1
    v_mul_u32_u24 v10, 5, v10
    v_add_u32 v10, v10, v9
    v_add_u32 v10, 5, v10
    v_and_b32 v11, 7, v255
    v_add_u32 v11, s29, v11
    v_lshl_add_u32 v10, v10, 4, v11
    s_lshr_b32 s30, s61, 2
    v_lshl_add_u32 v11, v9, 4, s30
    v_cmp_gt_u32 vcc, 32, v255
    s_nop 1
    v_cndmask_b32 v10, v11, v10, vcc
    v_lshlrev_b32 v240, 7, v10
L_p1_done:
    s_add_u32 s52, s24, 0xa60800
    s_addc_u32 s53, s25, 0
    s_mov_b32 s54, 0x8000
    s_mov_b32 s55, 0x00020000
    s_mov_b32 s67, 200000
L_p2_f1:
    buffer_load_dword v10, v240, s[52:55], 0 offen sc1
    s_waitcnt vmcnt(0)
    v_cmp_ne_u32 vcc, s26, v10
    s_cbranch_vccz L_p2_f1_ok
    s_sleep 2
    s_sub_u32 s67, s67, 1
    s_cmp_lg_u32 s67, 0
    s_cbranch_scc1 L_p2_f1
L_p2_f1_ok:
    buffer_load_dwordx4 v[184:187], v2, s[36:39], s58 offen sc1
    buffer_load_dwordx2 v[196:197], v3, s[36:39], s58 offen sc1
    buffer_load_dwordx2 v[24:25], v28, s[32:35], s64 offen sc1
    buffer_load_dwordx4 v[8:11], v2, s[32:35], s64 offen sc1
    s_add_u32 s64, s64, 512
    buffer_load_dwordx4 v[12:15], v2, s[32:35], s64 offen sc1
    s_add_u32 s64, s64, 512
    buffer_load_dwordx2 v[26:27], v28, s[32:35], s64 offen sc1
    buffer_load_dwordx4 v[16:19], v2, s[32:35], s64 offen sc1
    s_add_u32 s64, s64, 512
    buffer_load_dwordx4 v[20:23], v2, s[32:35], s64 offen sc1
    s_add_u32 s64, s64, 512
    buffer_load_dwordx4 v[188:191], v4, s[40:43], s60 offen sc1
    buffer_load_dwordx4 v[192:195], v5, s[40:43], s60 offen sc1
    s_add_u32 s58, s58, 512
    s_add_u32 s60, s60, 41216
    buffer_load_dwordx4 v[198:201], v2, s[36:39], s58 offen sc1
    buffer_load_dwordx2 v[210:211], v3, s[36:39], s58 offen sc1
    buffer_load_dwordx4 v[202:205], v4, s[40:43], s60 offen sc1
    buffer_load_dwordx4 v[206:209], v5, s[40:43], s60 offen sc1
    s_add_u32 s58, s58, 512
    s_add_u32 s60, s60, 41216
    buffer_load_dwordx4 v[212:215], v2, s[36:39], s58 offen sc1
    buffer_load_dwordx2 v[224:225], v3, s[36:39], s58 offen sc1
    buffer_load_dwordx4 v[216:219], v4, s[40:43], s60 offen sc1
    buffer_load_dwordx4 v[220:223], v5, s[40:43], s60 offen sc1
    s_add_u32 s58, s58, 512
    s_add_u32 s60, s60, 41216
    s_mul_i32 s29, s3, 6144
    s_add_u32 s29, s29, 102400
    v_add_u32 v0, s29, v1
    s_xor_b32 s30, s3, 2
    s_mul_i32 s30, s30, 6144
    s_add_u32 s30, s30, 102400
    v_add_u32 v6, s30, v1
    s_waitcnt vmcnt(13)
    v_mfma_f32_32x32x4_2b_bf16 v[104:135], v[196:197], v[24:25], 0
    s_nop 15
    s_nop 1
    v_mfma_f32_32x32x16_bf16 v[104:119], v[184:187], v[8:11], v[104:119]
    v_mfma_f32_32x32x16_bf16 v[120:135], v[184:187], v[12:15], v[120:135]
    s_waitcnt vmcnt(8)
    v_mov_b32 v242, 163340
    v_mov_b32 v243, 1
    s_mov_b64 exec, 1
    ds_add_u32 v242, v243
    s_mov_b64 exec, -1
    s_nop 6
.p2align 3
L_p2_loop:
    v_mfma_f32_32x32x16_bf16 v[72:87], v[230:233], v[168:171], v[72:87]
    buffer_load_dwordx4 v[226:229], v2, s[36:39], s58 offen sc1
    v_exp_f32 v104, v104
    v_exp_f32 v105, v105
    v_exp_f32 v106, v106
    v_exp_f32 v107, v107
    v_cvt_pk_bf16_f32 v168, v104, v105
    v_cvt_pk_bf16_f32 v169, v106, v107
    v_mfma_f32_32x32x16_bf16 v[72:87], v[234:237], v[172:175], v[72:87]
    v_exp_f32 v108, v108
    v_exp_f32 v109, v109
    v_exp_f32 v110, v110
    v_exp_f32 v111, v111
    v_cvt_pk_bf16_f32 v170, v108, v109
    v_cvt_pk_bf16_f32 v171, v110, v111
    v_mfma_f32_32x32x4_2b_bf16 v[136:167], v[196:197], v[26:27], 0
    v_exp_f32 v112, v112
    v_exp_f32 v113, v113
    v_exp_f32 v114, v114
    v_exp_f32 v115, v115
    v_cvt_pk_bf16_f32 v172, v112, v113
    v_cvt_pk_bf16_f32 v173, v114, v115
    v_exp_f32 v116, v116
    v_exp_f32 v117, v117
    v_exp_f32 v118, v118
    v_exp_f32 v119, v119
    v_cvt_pk_bf16_f32 v174, v116, v117
    v_cvt_pk_bf16_f32 v175, v118, v119
    v_mfma_f32_32x32x16_bf16 v[88:103], v[230:233], v[176:179], v[88:103]
    buffer_load_dwordx2 v[238:239], v3, s[36:39], s58 offen sc1
    v_exp_f32 v120, v120
    v_exp_f32 v121, v121
    v_exp_f32 v122, v122
    v_exp_f32 v123, v123
    v_cvt_pk_bf16_f32 v176, v120, v121
    v_cvt_pk_bf16_f32 v177, v122, v123
    v_mfma_f32_32x32x16_bf16 v[136:151], v[184:187], v[16:19], v[136:151]
    s_add_u32 s58, s58, 512
    v_exp_f32 v124, v124
    v_exp_f32 v125, v125
    v_exp_f32 v126, v126
    v_exp_f32 v127, v127
    v_cvt_pk_bf16_f32 v178, v124, v125
    v_cvt_pk_bf16_f32 v179, v126, v127
    v_mfma_f32_32x32x16_bf16 v[88:103], v[234:237], v[180:183], v[88:103]
    v_exp_f32 v128, v128
    v_exp_f32 v129, v129
    v_exp_f32 v130, v130
    v_exp_f32 v131, v131
    v_cvt_pk_bf16_f32 v180, v128, v129
    v_cvt_pk_bf16_f32 v181, v130, v131
    v_mfma_f32_32x32x16_bf16 v[152:167], v[184:187], v[20:23], v[152:167]
    s_waitcnt vmcnt(6)
    v_exp_f32 v132, v132
    v_exp_f32 v133, v133
    v_exp_f32 v134, v134
    v_exp_f32 v135, v135
    v_cvt_pk_bf16_f32 v182, v132, v133
    v_cvt_pk_bf16_f32 v183, v134, v135
    v_mfma_f32_32x32x16_bf16 v[40:55], v[188:191], v[168:171], v[40:55]
    buffer_load_dwordx4 v[230:233], v4, s[40:43], s60 offen sc1
    v_exp_f32 v136, v136
    v_exp_f32 v137, v137
    v_exp_f32 v138, v138
    v_exp_f32 v139, v139
    v_cvt_pk_bf16_f32 v168, v136, v137
    v_cvt_pk_bf16_f32 v169, v138, v139
    v_mfma_f32_32x32x16_bf16 v[40:55], v[192:195], v[172:175], v[40:55]
    v_exp_f32 v140, v140
    v_exp_f32 v141, v141
    v_exp_f32 v142, v142
    v_exp_f32 v143, v143
    v_cvt_pk_bf16_f32 v170, v140, v141
    v_cvt_pk_bf16_f32 v171, v142, v143
    v_mfma_f32_32x32x4_2b_bf16 v[104:135], v[210:211], v[24:25], 0
    v_exp_f32 v144, v144
    v_exp_f32 v145, v145
    v_exp_f32 v146, v146
    v_exp_f32 v147, v147
    v_cvt_pk_bf16_f32 v172, v144, v145
    v_cvt_pk_bf16_f32 v173, v146, v147
    v_exp_f32 v148, v148
    v_exp_f32 v149, v149
    v_exp_f32 v150, v150
    v_exp_f32 v151, v151
    v_cvt_pk_bf16_f32 v174, v148, v149
    v_cvt_pk_bf16_f32 v175, v150, v151
    v_mfma_f32_32x32x16_bf16 v[56:71], v[188:191], v[176:179], v[56:71]
    buffer_load_dwordx4 v[234:237], v5, s[40:43], s60 offen sc1
    v_exp_f32 v152, v152
    v_exp_f32 v153, v153
    v_exp_f32 v154, v154
    v_exp_f32 v155, v155
    v_cvt_pk_bf16_f32 v176, v152, v153
    v_cvt_pk_bf16_f32 v177, v154, v155
    v_mfma_f32_32x32x16_bf16 v[104:119], v[198:201], v[8:11], v[104:119]
    s_add_u32 s60, s60, 41216
    v_exp_f32 v156, v156
    v_exp_f32 v157, v157
    v_exp_f32 v158, v158
    v_exp_f32 v159, v159
    v_cvt_pk_bf16_f32 v178, v156, v157
    v_cvt_pk_bf16_f32 v179, v158, v159
    v_mfma_f32_32x32x16_bf16 v[56:71], v[192:195], v[180:183], v[56:71]
    v_exp_f32 v160, v160
    v_exp_f32 v161, v161
    v_exp_f32 v162, v162
    v_exp_f32 v163, v163
    v_cvt_pk_bf16_f32 v180, v160, v161
    v_cvt_pk_bf16_f32 v181, v162, v163
    v_mfma_f32_32x32x16_bf16 v[120:135], v[198:201], v[12:15], v[120:135]
    v_exp_f32 v164, v164
    v_exp_f32 v165, v165
    v_exp_f32 v166, v166
    v_exp_f32 v167, v167
    v_cvt_pk_bf16_f32 v182, v164, v165
    v_cvt_pk_bf16_f32 v183, v166, v167
    v_mfma_f32_32x32x16_bf16 v[72:87], v[188:191], v[168:171], v[72:87]
    buffer_load_dwordx4 v[184:187], v2, s[36:39], s58 offen sc1
    v_exp_f32 v104, v104
    v_exp_f32 v105, v105
    v_exp_f32 v106, v106
    v_exp_f32 v107, v107
    v_cvt_pk_bf16_f32 v168, v104, v105
    v_cvt_pk_bf16_f32 v169, v106, v107
    v_mfma_f32_32x32x16_bf16 v[72:87], v[192:195], v[172:175], v[72:87]
    v_exp_f32 v108, v108
    v_exp_f32 v109, v109
    v_exp_f32 v110, v110
    v_exp_f32 v111, v111
    v_cvt_pk_bf16_f32 v170, v108, v109
    v_cvt_pk_bf16_f32 v171, v110, v111
    v_mfma_f32_32x32x4_2b_bf16 v[136:167], v[210:211], v[26:27], 0
    v_exp_f32 v112, v112
    v_exp_f32 v113, v113
    v_exp_f32 v114, v114
    v_exp_f32 v115, v115
    v_cvt_pk_bf16_f32 v172, v112, v113
    v_cvt_pk_bf16_f32 v173, v114, v115
    v_exp_f32 v116, v116
    v_exp_f32 v117, v117
    v_exp_f32 v118, v118
    v_exp_f32 v119, v119
    v_cvt_pk_bf16_f32 v174, v116, v117
    v_cvt_pk_bf16_f32 v175, v118, v119
    v_mfma_f32_32x32x16_bf16 v[88:103], v[188:191], v[176:179], v[88:103]
    buffer_load_dwordx2 v[196:197], v3, s[36:39], s58 offen sc1
    v_exp_f32 v120, v120
    v_exp_f32 v121, v121
    v_exp_f32 v122, v122
    v_exp_f32 v123, v123
    v_cvt_pk_bf16_f32 v176, v120, v121
    v_cvt_pk_bf16_f32 v177, v122, v123
    v_mfma_f32_32x32x16_bf16 v[136:151], v[198:201], v[16:19], v[136:151]
    s_add_u32 s58, s58, 512
    v_exp_f32 v124, v124
    v_exp_f32 v125, v125
    v_exp_f32 v126, v126
    v_exp_f32 v127, v127
    v_cvt_pk_bf16_f32 v178, v124, v125
    v_cvt_pk_bf16_f32 v179, v126, v127
    v_mfma_f32_32x32x16_bf16 v[88:103], v[192:195], v[180:183], v[88:103]
    v_exp_f32 v128, v128
    v_exp_f32 v129, v129
    v_exp_f32 v130, v130
    v_exp_f32 v131, v131
    v_cvt_pk_bf16_f32 v180, v128, v129
    v_cvt_pk_bf16_f32 v181, v130, v131
    v_mfma_f32_32x32x16_bf16 v[152:167], v[198:201], v[20:23], v[152:167]
    s_waitcnt vmcnt(6)
    v_exp_f32 v132, v132
    v_exp_f32 v133, v133
    v_exp_f32 v134, v134
    v_exp_f32 v135, v135
    v_cvt_pk_bf16_f32 v182, v132, v133
    v_cvt_pk_bf16_f32 v183, v134, v135
    v_mfma_f32_32x32x16_bf16 v[40:55], v[202:205], v[168:171], v[40:55]
    buffer_load_dwordx4 v[188:191], v4, s[40:43], s60 offen sc1
    v_exp_f32 v136, v136
    v_exp_f32 v137, v137
    v_exp_f32 v138, v138
    v_exp_f32 v139, v139
    v_cvt_pk_bf16_f32 v168, v136, v137
    v_cvt_pk_bf16_f32 v169, v138, v139
    v_mfma_f32_32x32x16_bf16 v[40:55], v[206:209], v[172:175], v[40:55]
    v_exp_f32 v140, v140
    v_exp_f32 v141, v141
    v_exp_f32 v142, v142
    v_exp_f32 v143, v143
    v_cvt_pk_bf16_f32 v170, v140, v141
    v_cvt_pk_bf16_f32 v171, v142, v143
    v_mfma_f32_32x32x4_2b_bf16 v[104:135], v[224:225], v[24:25], 0
    v_exp_f32 v144, v144
    v_exp_f32 v145, v145
    v_exp_f32 v146, v146
    v_exp_f32 v147, v147
    v_cvt_pk_bf16_f32 v172, v144, v145
    v_cvt_pk_bf16_f32 v173, v146, v147
    v_exp_f32 v148, v148
    v_exp_f32 v149, v149
    v_exp_f32 v150, v150
    v_exp_f32 v151, v151
    v_cvt_pk_bf16_f32 v174, v148, v149
    v_cvt_pk_bf16_f32 v175, v150, v151
    v_mfma_f32_32x32x16_bf16 v[56:71], v[202:205], v[176:179], v[56:71]
    buffer_load_dwordx4 v[192:195], v5, s[40:43], s60 offen sc1
    v_exp_f32 v152, v152
    v_exp_f32 v153, v153
    v_exp_f32 v154, v154
    v_exp_f32 v155, v155
    v_cvt_pk_bf16_f32 v176, v152, v153
    v_cvt_pk_bf16_f32 v177, v154, v155
    v_mfma_f32_32x32x16_bf16 v[104:119], v[212:215], v[8:11], v[104:119]
    s_add_u32 s60, s60, 41216
    v_exp_f32 v156, v156
    v_exp_f32 v157, v157
    v_exp_f32 v158, v158
    v_exp_f32 v159, v159
    v_cvt_pk_bf16_f32 v178, v156, v157
    v_cvt_pk_bf16_f32 v179, v158, v159
    v_mfma_f32_32x32x16_bf16 v[56:71], v[206:209], v[180:183], v[56:71]
    v_exp_f32 v160, v160
    v_exp_f32 v161, v161
    v_exp_f32 v162, v162
    v_exp_f32 v163, v163
    v_cvt_pk_bf16_f32 v180, v160, v161
    v_cvt_pk_bf16_f32 v181, v162, v163
    v_mfma_f32_32x32x16_bf16 v[120:135], v[212:215], v[12:15], v[120:135]
    v_exp_f32 v164, v164
    v_exp_f32 v165, v165
    v_exp_f32 v166, v166
    v_exp_f32 v167, v167
    v_cvt_pk_bf16_f32 v182, v164, v165
    v_cvt_pk_bf16_f32 v183, v166, v167
    v_mfma_f32_32x32x16_bf16 v[72:87], v[202:205], v[168:171], v[72:87]
    buffer_load_dwordx4 v[198:201], v2, s[36:39], s58 offen sc1
    v_exp_f32 v104, v104
    v_exp_f32 v105, v105
    v_exp_f32 v106, v106
    v_exp_f32 v107, v107
    v_cvt_pk_bf16_f32 v168, v104, v105
    v_cvt_pk_bf16_f32 v169, v106, v107
    v_mfma_f32_32x32x16_bf16 v[72:87], v[206:209], v[172:175], v[72:87]
    v_exp_f32 v108, v108
    v_exp_f32 v109, v109
    v_exp_f32 v110, v110
    v_exp_f32 v111, v111
    v_cvt_pk_bf16_f32 v170, v108, v109
    v_cvt_pk_bf16_f32 v171, v110, v111
    v_mfma_f32_32x32x4_2b_bf16 v[136:167], v[224:225], v[26:27], 0
    v_exp_f32 v112, v112
    v_exp_f32 v113, v113
    v_exp_f32 v114, v114
    v_exp_f32 v115, v115
    v_cvt_pk_bf16_f32 v172, v112, v113
    v_cvt_pk_bf16_f32 v173, v114, v115
    v_exp_f32 v116, v116
    v_exp_f32 v117, v117
    v_exp_f32 v118, v118
    v_exp_f32 v119, v119
    v_cvt_pk_bf16_f32 v174, v116, v117
    v_cvt_pk_bf16_f32 v175, v118, v119
    v_mfma_f32_32x32x16_bf16 v[88:103], v[202:205], v[176:179], v[88:103]
    buffer_load_dwordx2 v[210:211], v3, s[36:39], s58 offen sc1
    v_exp_f32 v120, v120
    v_exp_f32 v121, v121
    v_exp_f32 v122, v122
    v_exp_f32 v123, v123
    v_cvt_pk_bf16_f32 v176, v120, v121
    v_cvt_pk_bf16_f32 v177, v122, v123
    v_mfma_f32_32x32x16_bf16 v[136:151], v[212:215], v[16:19], v[136:151]
    s_add_u32 s58, s58, 512
    v_exp_f32 v124, v124
    v_exp_f32 v125, v125
    v_exp_f32 v126, v126
    v_exp_f32 v127, v127
    v_cvt_pk_bf16_f32 v178, v124, v125
    v_cvt_pk_bf16_f32 v179, v126, v127
    v_mfma_f32_32x32x16_bf16 v[88:103], v[206:209], v[180:183], v[88:103]
    v_exp_f32 v128, v128
    v_exp_f32 v129, v129
    v_exp_f32 v130, v130
    v_exp_f32 v131, v131
    v_cvt_pk_bf16_f32 v180, v128, v129
    v_cvt_pk_bf16_f32 v181, v130, v131
    v_mfma_f32_32x32x16_bf16 v[152:167], v[212:215], v[20:23], v[152:167]
    s_waitcnt vmcnt(6)
    v_exp_f32 v132, v132
    v_exp_f32 v133, v133
    v_exp_f32 v134, v134
    v_exp_f32 v135, v135
    v_cvt_pk_bf16_f32 v182, v132, v133
    v_cvt_pk_bf16_f32 v183, v134, v135
    v_mfma_f32_32x32x16_bf16 v[40:55], v[216:219], v[168:171], v[40:55]
    buffer_load_dwordx4 v[202:205], v4, s[40:43], s60 offen sc1
    v_exp_f32 v136, v136
    v_exp_f32 v137, v137
    v_exp_f32 v138, v138
    v_exp_f32 v139, v139
    v_cvt_pk_bf16_f32 v168, v136, v137
    v_cvt_pk_bf16_f32 v169, v138, v139
    v_mfma_f32_32x32x16_bf16 v[40:55], v[220:223], v[172:175], v[40:55]
    v_exp_f32 v140, v140
    v_exp_f32 v141, v141
    v_exp_f32 v142, v142
    v_exp_f32 v143, v143
    v_cvt_pk_bf16_f32 v170, v140, v141
    v_cvt_pk_bf16_f32 v171, v142, v143
    v_mfma_f32_32x32x4_2b_bf16 v[104:135], v[238:239], v[24:25], 0
    v_exp_f32 v144, v144
    v_exp_f32 v145, v145
    v_exp_f32 v146, v146
    v_exp_f32 v147, v147
    v_cvt_pk_bf16_f32 v172, v144, v145
    v_cvt_pk_bf16_f32 v173, v146, v147
    v_exp_f32 v148, v148
    v_exp_f32 v149, v149
    v_exp_f32 v150, v150
    v_exp_f32 v151, v151
    v_cvt_pk_bf16_f32 v174, v148, v149
    v_cvt_pk_bf16_f32 v175, v150, v151
    v_mfma_f32_32x32x16_bf16 v[56:71], v[216:219], v[176:179], v[56:71]
    buffer_load_dwordx4 v[206:209], v5, s[40:43], s60 offen sc1
    v_exp_f32 v152, v152
    v_exp_f32 v153, v153
    v_exp_f32 v154, v154
    v_exp_f32 v155, v155
    v_cvt_pk_bf16_f32 v176, v152, v153
    v_cvt_pk_bf16_f32 v177, v154, v155
    v_mfma_f32_32x32x16_bf16 v[104:119], v[226:229], v[8:11], v[104:119]
    s_add_u32 s60, s60, 41216
    v_exp_f32 v156, v156
    v_exp_f32 v157, v157
    v_exp_f32 v158, v158
    v_exp_f32 v159, v159
    v_cvt_pk_bf16_f32 v178, v156, v157
    v_cvt_pk_bf16_f32 v179, v158, v159
    v_mfma_f32_32x32x16_bf16 v[56:71], v[220:223], v[180:183], v[56:71]
    v_exp_f32 v160, v160
    v_exp_f32 v161, v161
    v_exp_f32 v162, v162
    v_exp_f32 v163, v163
    v_cvt_pk_bf16_f32 v180, v160, v161
    v_cvt_pk_bf16_f32 v181, v162, v163
    v_mfma_f32_32x32x16_bf16 v[120:135], v[226:229], v[12:15], v[120:135]
    v_exp_f32 v164, v164
    v_exp_f32 v165, v165
    v_exp_f32 v166, v166
    v_exp_f32 v167, v167
    v_cvt_pk_bf16_f32 v182, v164, v165
    v_cvt_pk_bf16_f32 v183, v166, v167
    v_mfma_f32_32x32x16_bf16 v[72:87], v[216:219], v[168:171], v[72:87]
    buffer_load_dwordx4 v[212:215], v2, s[36:39], s58 offen sc1
    v_exp_f32 v104, v104
    v_exp_f32 v105, v105
    v_exp_f32 v106, v106
    v_exp_f32 v107, v107
    v_cvt_pk_bf16_f32 v168, v104, v105
    v_cvt_pk_bf16_f32 v169, v106, v107
    v_mfma_f32_32x32x16_bf16 v[72:87], v[220:223], v[172:175], v[72:87]
    v_exp_f32 v108, v108
    v_exp_f32 v109, v109
    v_exp_f32 v110, v110
    v_exp_f32 v111, v111
    v_cvt_pk_bf16_f32 v170, v108, v109
    v_cvt_pk_bf16_f32 v171, v110, v111
    v_mfma_f32_32x32x4_2b_bf16 v[136:167], v[238:239], v[26:27], 0
    v_exp_f32 v112, v112
    v_exp_f32 v113, v113
    v_exp_f32 v114, v114
    v_exp_f32 v115, v115
    v_cvt_pk_bf16_f32 v172, v112, v113
    v_cvt_pk_bf16_f32 v173, v114, v115
    v_exp_f32 v116, v116
    v_exp_f32 v117, v117
    v_exp_f32 v118, v118
    v_exp_f32 v119, v119
    v_cvt_pk_bf16_f32 v174, v116, v117
    v_cvt_pk_bf16_f32 v175, v118, v119
    v_mfma_f32_32x32x16_bf16 v[88:103], v[216:219], v[176:179], v[88:103]
    buffer_load_dwordx2 v[224:225], v3, s[36:39], s58 offen sc1
    v_exp_f32 v120, v120
    v_exp_f32 v121, v121
    v_exp_f32 v122, v122
    v_exp_f32 v123, v123
    v_cvt_pk_bf16_f32 v176, v120, v121
    v_cvt_pk_bf16_f32 v177, v122, v123
    v_mfma_f32_32x32x16_bf16 v[136:151], v[226:229], v[16:19], v[136:151]
    s_add_u32 s58, s58, 512
    v_exp_f32 v124, v124
    v_exp_f32 v125, v125
    v_exp_f32 v126, v126
    v_exp_f32 v127, v127
    v_cvt_pk_bf16_f32 v178, v124, v125
    v_cvt_pk_bf16_f32 v179, v126, v127
    v_mfma_f32_32x32x16_bf16 v[88:103], v[220:223], v[180:183], v[88:103]
    v_exp_f32 v128, v128
    v_exp_f32 v129, v129
    v_exp_f32 v130, v130
    v_exp_f32 v131, v131
    v_cvt_pk_bf16_f32 v180, v128, v129
    v_cvt_pk_bf16_f32 v181, v130, v131
    v_mfma_f32_32x32x16_bf16 v[152:167], v[226:229], v[20:23], v[152:167]
    s_waitcnt vmcnt(6)
    v_exp_f32 v132, v132
    v_exp_f32 v133, v133
    v_exp_f32 v134, v134
    v_exp_f32 v135, v135
    v_cvt_pk_bf16_f32 v182, v132, v133
    v_cvt_pk_bf16_f32 v183, v134, v135
    v_mfma_f32_32x32x16_bf16 v[40:55], v[230:233], v[168:171], v[40:55]
    buffer_load_dwordx4 v[216:219], v4, s[40:43], s60 offen sc1
    v_exp_f32 v136, v136
    v_exp_f32 v137, v137
    v_exp_f32 v138, v138
    v_exp_f32 v139, v139
    v_cvt_pk_bf16_f32 v168, v136, v137
    v_cvt_pk_bf16_f32 v169, v138, v139
    v_mfma_f32_32x32x16_bf16 v[40:55], v[234:237], v[172:175], v[40:55]
    v_exp_f32 v140, v140
    v_exp_f32 v141, v141
    v_exp_f32 v142, v142
    v_exp_f32 v143, v143
    v_cvt_pk_bf16_f32 v170, v140, v141
    v_cvt_pk_bf16_f32 v171, v142, v143
    v_mfma_f32_32x32x4_2b_bf16 v[104:135], v[196:197], v[24:25], 0
    v_exp_f32 v144, v144
    v_exp_f32 v145, v145
    v_exp_f32 v146, v146
    v_exp_f32 v147, v147
    v_cvt_pk_bf16_f32 v172, v144, v145
    v_cvt_pk_bf16_f32 v173, v146, v147
    v_exp_f32 v148, v148
    v_exp_f32 v149, v149
    v_exp_f32 v150, v150
    v_exp_f32 v151, v151
    v_cvt_pk_bf16_f32 v174, v148, v149
    v_cvt_pk_bf16_f32 v175, v150, v151
    v_mfma_f32_32x32x16_bf16 v[56:71], v[230:233], v[176:179], v[56:71]
    buffer_load_dwordx4 v[220:223], v5, s[40:43], s60 offen sc1
    v_exp_f32 v152, v152
    v_exp_f32 v153, v153
    v_exp_f32 v154, v154
    v_exp_f32 v155, v155
    v_cvt_pk_bf16_f32 v176, v152, v153
    v_cvt_pk_bf16_f32 v177, v154, v155
    v_mfma_f32_32x32x16_bf16 v[104:119], v[184:187], v[8:11], v[104:119]
    s_add_u32 s60, s60, 41216
    v_exp_f32 v156, v156
    v_exp_f32 v157, v157
    v_exp_f32 v158, v158
    v_exp_f32 v159, v159
    v_cvt_pk_bf16_f32 v178, v156, v157
    v_cvt_pk_bf16_f32 v179, v158, v159
    v_mfma_f32_32x32x16_bf16 v[56:71], v[234:237], v[180:183], v[56:71]
    s_sub_u32 s59, s59, 1
    v_exp_f32 v160, v160
    v_exp_f32 v161, v161
    v_exp_f32 v162, v162
    v_exp_f32 v163, v163
    v_cvt_pk_bf16_f32 v180, v160, v161
    v_cvt_pk_bf16_f32 v181, v162, v163
    v_mfma_f32_32x32x16_bf16 v[120:135], v[184:187], v[12:15], v[120:135]
    s_cmp_lg_u32 s59, 0
    v_exp_f32 v164, v164
    v_exp_f32 v165, v165
    v_exp_f32 v166, v166
    v_exp_f32 v167, v167
    v_cvt_pk_bf16_f32 v182, v164, v165
    v_cvt_pk_bf16_f32 v183, v166, v167
    s_cbranch_scc1 L_p2_loop
    v_mfma_f32_32x32x16_bf16 v[72:87], v[230:233], v[168:171], v[72:87]
    v_mfma_f32_32x32x16_bf16 v[88:103], v[230:233], v[176:179], v[88:103]
    v_mfma_f32_32x32x16_bf16 v[72:87], v[234:237], v[172:175], v[72:87]
    v_mfma_f32_32x32x16_bf16 v[88:103], v[234:237], v[180:183], v[88:103]
    s_mov_b32 s72, 0
L_p2_xch:
    s_and_b32 s29, s2, 7
    s_lshr_b32 s30, s2, 3
    s_and_b32 s31, s30, 3
    s_lshl_b32 s29, s29, 2
    s_add_u32 s66, s29, s31
    s_lshr_b32 s70, s30, 2
    s_mov_b32 s32, s4
    s_mov_b32 s33, s5
    s_mov_b32 s34, 0x280000
    s_mov_b32 s35, 0x00020000
    s_add_u32 s36, s24, 0xa58800
    s_addc_u32 s37, s25, 0
    s_mov_b32 s38, 0x8000
    s_mov_b32 s39, 0x00020000
    s_add_u32 s40, s24, 0xa50700
    s_addc_u32 s41, s25, 0
    s_mov_b32 s42, 0x10
    s_mov_b32 s43, 0x00020000
    v_and_b32 v30, 15, v255
    v_lshrrev_b32 v31, 4, v255
    s_and_b32 s58, s3, 1
    s_lshr_b32 s59, s3, 1
    s_lshl_b32 s60, s66, 1
    s_add_u32 s60, s60, s58
    s_lshl_b32 s29, s60, 5
    s_lshl_b32 s30, s59, 4
    s_add_u32 s29, s29, s30
    v_add_u32 v37, s29, v30
    v_mul_u32_u24 v29, 1280, v37
    s_mul_i32 s29, s70, 160
    v_lshl_add_u32 v29, v31, 3, v29
    v_add_u32 v29, s29, v29
    s_and_b32 s30, s66, 3
    s_lshl_b32 s30, s30, 6
    s_lshr_b32 s29, s66, 3
    s_add_u32 s30, s30, s29
    s_and_b32 s29, s66, 4
    s_add_u32 s30, s30, s29
    v_and_b32 v38, 7, v255
    v_lshl_add_u32 v38, v38, 3, s30
    v_lshlrev_b32 v38, 7, v38
    v_mov_b32 v39, 0
    buffer_load_dwordx2 v[228:229], v29, s[32:35], 0 offen offset:0
    buffer_load_dwordx2 v[230:231], v29, s[32:35], 0 offen offset:32
    buffer_load_dwordx2 v[232:233], v29, s[32:35], 0 offen offset:64
    buffer_load_dwordx2 v[234:235], v29, s[32:35], 0 offen offset:96
    buffer_load_dwordx2 v[236:237], v29, s[32:35], 0 offen offset:128
    buffer_load_dword v36, v38, s[36:39], 0 offen sc1
    buffer_load_dwordx4 v[32:35], v39, s[40:43], 0 offen sc1
    s_mov_b32 s73, 0x207
    s_mov_b32 s74, 0x17800000
    s_mov_b32 s75, 0x76800000
    s_mov_b64 s[76:77], 0
    s_cmp_ge_u32 s3, 2
    s_cbranch_scc1 L_p2_wk1
    ds_write_b128 v0, v[72:75] offset:0
    ds_write_b128 v0, v[76:79] offset:1024
    ds_write_b128 v0, v[80:83] offset:2048
    ds_write_b128 v0, v[88:91] offset:3072
    ds_write_b128 v0, v[92:95] offset:4096
    ds_write_b128 v0, v[96:99] offset:5120
    s_waitcnt lgkmcnt(0)
    s_barrier
    ds_read_b128 v[104:107], v6 offset:0
    ds_read_b128 v[108:111], v6 offset:1024
    ds_read_b128 v[112:115], v6 offset:2048
    ds_read_b128 v[116:119], v6 offset:3072
    ds_read_b128 v[120:123], v6 offset:4096
    ds_read_b128 v[124:127], v6 offset:5120
    s_waitcnt lgkmcnt(3)
    v_add_f32 v48, v48, v112
    v_mov_b32 v112, v48
    v_mov_b32 v128, v48
    v_add_f32 v49, v49, v113
    v_add_f32 v50, v50, v114
    v_add_f32 v51, v51, v115
    v_add_f32 v40, v40, v104
    v_add_f32 v41, v41, v105
    v_permlane32_swap_b32 v112, v128
    v_add_f32 v42, v42, v106
    v_add_f32 v43, v43, v107
    v_add_f32 v44, v44, v108
    v_rcp_f32 v130, v128
    v_add_f32 v45, v45, v109
    v_add_f32 v46, v46, v110
    v_add_f32 v47, v47, v111
    s_waitcnt lgkmcnt(0)
    v_add_f32 v64, v64, v124
    v_mov_b32 v124, v64
    v_mov_b32 v129, v64
    v_add_f32 v65, v65, v125
    v_add_f32 v66, v66, v126
    v_add_f32 v67, v67, v127
    v_add_f32 v56, v56, v116
    v_add_f32 v57, v57, v117
    v_permlane32_swap_b32 v124, v129
    v_add_f32 v58, v58, v118
    v_add_f32 v59, v59, v119
    v_add_f32 v60, v60, v120
    v_rcp_f32 v131, v129
    v_add_f32 v61, v61, v121
    v_add_f32 v62, v62, v122
    v_add_f32 v63, v63, v123
    v_mul_f32 v40, v40, v130
    v_mul_f32 v41, v41, v130
    v_mul_f32 v42, v42, v130
    v_mul_f32 v43, v43, v130
    v_mul_f32 v44, v44, v130
    v_mul_f32 v45, v45, v130
    v_mul_f32 v46, v46, v130
    v_mul_f32 v47, v47, v130
    v_mul_f32 v48, v48, v130
    v_mul_f32 v49, v49, v130
    v_mul_f32 v50, v50, v130
    v_mul_f32 v51, v51, v130
    v_cvt_pk_bf16_f32 v104, v40, v41
    v_cvt_pk_bf16_f32 v105, v42, v43
    v_cvt_pk_bf16_f32 v106, v44, v45
    v_cvt_pk_bf16_f32 v107, v46, v47
    v_cvt_pk_bf16_f32 v108, v48, v49
    v_cvt_pk_bf16_f32 v109, v50, v51
    s_add_u32 s31, s61, 0
    s_lshl_b32 s31, s31, 5
    s_add_u32 s31, s31, s56
    s_lshl_b32 s64, s31, 10
    s_lshl_b32 s65, s31, 8
    buffer_store_dwordx4 v[104:107], v1, s[44:47], s64 offen sc1
    buffer_store_dwordx2 v[108:109], v7, s[48:51], s65 offen sc1
    v_mul_f32 v56, v56, v131
    v_mul_f32 v57, v57, v131
    v_mul_f32 v58, v58, v131
    v_mul_f32 v59, v59, v131
    v_mul_f32 v60, v60, v131
    v_mul_f32 v61, v61, v131
    v_mul_f32 v62, v62, v131
    v_mul_f32 v63, v63, v131
    v_mul_f32 v64, v64, v131
    v_mul_f32 v65, v65, v131
    v_mul_f32 v66, v66, v131
    v_mul_f32 v67, v67, v131
    v_cvt_pk_bf16_f32 v116, v56, v57
    v_cvt_pk_bf16_f32 v117, v58, v59
    v_cvt_pk_bf16_f32 v118, v60, v61
    v_cvt_pk_bf16_f32 v119, v62, v63
    v_cvt_pk_bf16_f32 v120, v64, v65
    v_cvt_pk_bf16_f32 v121, v66, v67
    s_add_u32 s31, s61, 1
    s_lshl_b32 s31, s31, 5
    s_add_u32 s31, s31, s56
    s_lshl_b32 s64, s31, 10
    s_lshl_b32 s65, s31, 8
    buffer_store_dwordx4 v[116:119], v1, s[44:47], s64 offen sc1
    buffer_store_dwordx2 v[120:121], v7, s[48:51], s65 offen sc1
    v_add_f32 v132, v40, v41
    v_add_f32 v132, v132, v42
    v_add_f32 v132, v132, v43
    v_add_f32 v132, v132, v44
    v_add_f32 v132, v132, v45
    v_add_f32 v132, v132, v46
    v_add_f32 v132, v132, v47
    v_add_f32 v132, v132, v48
    v_add_f32 v132, v132, v49
    v_add_f32 v132, v132, v50
    v_add_f32 v132, v132, v51
    v_cmp_class_f32 vcc, v132, s73
    v_cmp_nle_f32 s[30:31], s74, v128
    s_or_b64 vcc, vcc, s[30:31]
    v_cmp_nge_f32 s[30:31], s75, v128
    s_or_b64 s[76:77], s[76:77], vcc
    s_or_b64 s[76:77], s[76:77], s[30:31]
    v_add_f32 v132, v56, v57
    v_add_f32 v132, v132, v58
    v_add_f32 v132, v132, v59
    v_add_f32 v132, v132, v60
    v_add_f32 v132, v132, v61
    v_add_f32 v132, v132, v62
    v_add_f32 v132, v132, v63
    v_add_f32 v132, v132, v64
    v_add_f32 v132, v132, v65
    v_add_f32 v132, v132, v66
    v_add_f32 v132, v132, v67
    v_cmp_class_f32 vcc, v132, s73
    v_cmp_nle_f32 s[30:31], s74, v129
    s_or_b64 vcc, vcc, s[30:31]
    v_cmp_nge_f32 s[30:31], s75, v129
    s_or_b64 s[76:77], s[76:77], vcc
    s_or_b64 s[76:77], s[76:77], s[30:31]
    s_branch L_p2_stored
L_p2_wk1:
    ds_write_b128 v0, v[40:43] offset:0
    ds_write_b128 v0, v[44:47] offset:1024
    ds_write_b128 v0, v[48:51] offset:2048
    ds_write_b128 v0, v[56:59] offset:3072
    ds_write_b128 v0, v[60:63] offset:4096
    ds_write_b128 v0, v[64:67] offset:5120
    s_waitcnt lgkmcnt(0)
    s_barrier
    ds_read_b128 v[104:107], v6 offset:0
    ds_read_b128 v[108:111], v6 offset:1024
    ds_read_b128 v[112:115], v6 offset:2048
    ds_read_b128 v[116:119], v6 offset:3072
    ds_read_b128 v[120:123], v6 offset:4096
    ds_read_b128 v[124:127], v6 offset:5120
    s_waitcnt lgkmcnt(3)
    v_add_f32 v80, v80, v112
    v_mov_b32 v112, v80
    v_mov_b32 v128, v80
    v_add_f32 v81, v81, v113
    v_add_f32 v82, v82, v114
    v_add_f32 v83, v83, v115
    v_add_f32 v72, v72, v104
    v_add_f32 v73, v73, v105
    v_permlane32_swap_b32 v112, v128
    v_add_f32 v74, v74, v106
    v_add_f32 v75, v75, v107
    v_add_f32 v76, v76, v108
    v_rcp_f32 v130, v128
    v_add_f32 v77, v77, v109
    v_add_f32 v78, v78, v110
    v_add_f32 v79, v79, v111
    s_waitcnt lgkmcnt(0)
    v_add_f32 v96, v96, v124
    v_mov_b32 v124, v96
    v_mov_b32 v129, v96
    v_add_f32 v97, v97, v125
    v_add_f32 v98, v98, v126
    v_add_f32 v99, v99, v127
    v_add_f32 v88, v88, v116
    v_add_f32 v89, v89, v117
    v_permlane32_swap_b32 v124, v129
    v_add_f32 v90, v90, v118
    v_add_f32 v91, v91, v119
    v_add_f32 v92, v92, v120
    v_rcp_f32 v131, v129
    v_add_f32 v93, v93, v121
    v_add_f32 v94, v94, v122
    v_add_f32 v95, v95, v123
    v_mul_f32 v72, v72, v130
    v_mul_f32 v73, v73, v130
    v_mul_f32 v74, v74, v130
    v_mul_f32 v75, v75, v130
    v_mul_f32 v76, v76, v130
    v_mul_f32 v77, v77, v130
    v_mul_f32 v78, v78, v130
    v_mul_f32 v79, v79, v130
    v_mul_f32 v80, v80, v130
    v_mul_f32 v81, v81, v130
    v_mul_f32 v82, v82, v130
    v_mul_f32 v83, v83, v130
    v_cvt_pk_bf16_f32 v104, v72, v73
    v_cvt_pk_bf16_f32 v105, v74, v75
    v_cvt_pk_bf16_f32 v106, v76, v77
    v_cvt_pk_bf16_f32 v107, v78, v79
    v_cvt_pk_bf16_f32 v108, v80, v81
    v_cvt_pk_bf16_f32 v109, v82, v83
    s_add_u32 s31, s61, 2
    s_lshl_b32 s31, s31, 5
    s_add_u32 s31, s31, s56
    s_lshl_b32 s64, s31, 10
    s_lshl_b32 s65, s31, 8
    buffer_store_dwordx4 v[104:107], v1, s[44:47], s64 offen sc1
    buffer_store_dwordx2 v[108:109], v7, s[48:51], s65 offen sc1
    v_mul_f32 v88, v88, v131
    v_mul_f32 v89, v89, v131
    v_mul_f32 v90, v90, v131
    v_mul_f32 v91, v91, v131
    v_mul_f32 v92, v92, v131
    v_mul_f32 v93, v93, v131
    v_mul_f32 v94, v94, v131
    v_mul_f32 v95, v95, v131
    v_mul_f32 v96, v96, v131
    v_mul_f32 v97, v97, v131
    v_mul_f32 v98, v98, v131
    v_mul_f32 v99, v99, v131
    v_cvt_pk_bf16_f32 v116, v88, v89
    v_cvt_pk_bf16_f32 v117, v90, v91
    v_cvt_pk_bf16_f32 v118, v92, v93
    v_cvt_pk_bf16_f32 v119, v94, v95
    v_cvt_pk_bf16_f32 v120, v96, v97
    v_cvt_pk_bf16_f32 v121, v98, v99
    s_add_u32 s31, s61, 3
    s_lshl_b32 s31, s31, 5
    s_add_u32 s31, s31, s56
    s_lshl_b32 s64, s31, 10
    s_lshl_b32 s65, s31, 8
    buffer_store_dwordx4 v[116:119], v1, s[44:47], s64 offen sc1
    buffer_store_dwordx2 v[120:121], v7, s[48:51], s65 offen sc1
    v_add_f32 v132, v72, v73
    v_add_f32 v132, v132, v74
    v_add_f32 v132, v132, v75
    v_add_f32 v132, v132, v76
    v_add_f32 v132, v132, v77
    v_add_f32 v132, v132, v78
    v_add_f32 v132, v132, v79
    v_add_f32 v132, v132, v80
    v_add_f32 v132, v132, v81
    v_add_f32 v132, v132, v82
    v_add_f32 v132, v132, v83
    v_cmp_class_f32 vcc, v132, s73
    v_cmp_nle_f32 s[30:31], s74, v128
    s_or_b64 vcc, vcc, s[30:31]
    v_cmp_nge_f32 s[30:31], s75, v128
    s_or_b64 s[76:77], s[76:77], vcc
    s_or_b64 s[76:77], s[76:77], s[30:31]
    v_add_f32 v132, v88, v89
    v_add_f32 v132, v132, v90
    v_add_f32 v132, v132, v91
    v_add_f32 v132, v132, v92
    v_add_f32 v132, v132, v93
    v_add_f32 v132, v132, v94
    v_add_f32 v132, v132, v95
    v_add_f32 v132, v132, v96
    v_add_f32 v132, v132, v97
    v_add_f32 v132, v132, v98
    v_add_f32 v132, v132, v99
    v_cmp_class_f32 vcc, v132, s73
    v_cmp_nle_f32 s[30:31], s74, v129
    s_or_b64 vcc, vcc, s[30:31]
    v_cmp_nge_f32 s[30:31], s75, v129
    s_or_b64 s[76:77], s[76:77], vcc
    s_or_b64 s[76:77], s[76:77], s[30:31]
L_p2_stored:
    s_cmp_eq_u64 s[76:77], 0
    s_cbranch_scc1 L_p2_good
    v_mov_b32 v244, 163336
    v_mov_b32 v245, 1
    ds_write_b32 v244, v245
    s_waitcnt lgkmcnt(0)
L_p2_good:
    s_lshl_b32 s71, s57, 5
    s_add_u32 s71, s71, s56
    s_add_u32 s52, s24, 0xa68800
    s_addc_u32 s53, s25, 0
    s_mov_b32 s54, 0x8000
    s_mov_b32 s55, 0x00020000
    s_lshl_b32 s29, s71, 7
    v_mov_b32 v246, s29
    v_mov_b32 v247, s26
    s_waitcnt vmcnt(0)
    s_barrier
    v_mov_b32 v244, 163336
    ds_read_b32 v245, v244
    s_waitcnt lgkmcnt(0)
    v_readfirstlane_b32 s29, v245
    s_sub_u32 s29, s29, s72
    s_cmp_gt_i32 s29, 0
    s_cbranch_scc1 L_p2_fallback
    s_cmp_lg_u32 s3, 0
    s_cbranch_scc1 L_p2_flagged
    s_mov_b64 exec, 1
    buffer_store_dword v247, v246, s[52:55], 0 offen sc1
    s_mov_b64 exec, -1
L_p2_flagged:
    s_add_u32 s44, s24, 0x784400
    s_addc_u32 s45, s25, 0
    s_mov_b32 s46, 0x200000
    s_mov_b32 s47, 0x00020000
    s_add_u32 s32, s24, 0x984500
    s_addc_u32 s33, s25, 0
    s_mov_b32 s34, 0x80000
    s_mov_b32 s35, 0x00020000
    s_add_u32 s48, s24, 0xa68800
    s_addc_u32 s49, s25, 0
    s_mov_b32 s50, 0x8000
    s_mov_b32 s51, 0x00020000
    v_mov_b32 v3, v30
    v_mov_b32 v4, v31
    v_lshrrev_b32 v6, 1, v4
    v_and_b32 v7, 1, v4
    v_lshlrev_b32 v20, 10, v6
    v_lshl_add_u32 v20, v7, 9, v20
    v_lshl_add_u32 v17, v3, 4, v20
    v_lshlrev_b32 v20, 9, v4
    v_lshl_add_u32 v18, v3, 3, v20
    s_lshl_b32 s61, s60, 15
    s_lshl_b32 s29, s59, 14
    s_add_u32 s61, s61, s29
    s_lshl_b32 s62, s60, 13
    s_lshl_b32 s29, s59, 12
    s_add_u32 s62, s62, s29
    v_bfe_u32 v22, v255, 2, 2
    v_and_b32 v23, 3, v255
    v_mul_u32_u24 v20, 20, v6
    v_lshl_add_u32 v20, v7, 2, v20
    v_add_u32 v20, v20, v22
    v_mul_u32_u24 v20, 160, v20
    v_lshl_add_u32 v14, v23, 3, v20
    s_mul_i32 s29, s59, 51200
    v_add_u32 v14, s29, v14
    v_mul_u32_u24 v20, 40, v4
    v_add_u32 v20, 16, v20
    v_add_u32 v20, v20, v22
    v_mul_u32_u24 v20, 160, v20
    v_lshl_add_u32 v15, v23, 3, v20
    s_mul_i32 s29, s59, 51200
    v_add_u32 v15, s29, v15
    s_lshr_b32 s29, s66, 2
    s_lshl_b32 s29, s29, 5
    s_lshl_b32 s30, s59, 4
    s_add_u32 s29, s29, s30
    v_add_u32 v16, s29, v3
    v_lshlrev_b32 v16, 7, v16
    buffer_load_dword v20, v16, s[48:51], 0 offen sc1
    s_waitcnt vmcnt(0)
    s_mov_b32 s67, 200000
L_p3_pres:
    v_cmp_ne_u32 vcc, s26, v36
    v_readfirstlane_b32 s63, v32
    v_readfirstlane_b32 s29, v33
    v_readfirstlane_b32 s64, v34
    v_readfirstlane_b32 s30, v35
    s_xor_b32 s29, s29, s26
    s_xor_b32 s30, s30, s26
    s_or_b32 s29, s29, s30
    s_or_b32 s29, s29, vcc_lo
    s_or_b32 s29, s29, vcc_hi
    s_cmp_eq_u32 s29, 0
    s_cbranch_scc1 L_p3_pre_oks
    s_sleep 4
    buffer_load_dword v36, v38, s[36:39], 0 offen sc1
    buffer_load_dwordx4 v[32:35], v39, s[40:43], 0 offen sc1
    s_waitcnt vmcnt(0)
    s_sub_u32 s67, s67, 1
    s_cmp_lg_u32 s67, 0
    s_cbranch_scc1 L_p3_pres
L_p3_pre_oks:
    s_add_u32 s36, s24, 0xa04600
    s_addc_u32 s37, s25, 0
    s_mov_b32 s38, 0x4000
    s_mov_b32 s39, 0x00020000
    v_lshlrev_b32 v22, 3, v37
    buffer_load_dwordx2 v[224:225], v22, s[36:39], 0 offen sc1
    v_mov_b32 v25, 268435456
    s_lshr_b32 s29, s63, 6
    s_lshr_b32 s30, s64, 6
    s_cmp_eq_u32 s29, s66
    s_cbranch_scc1 L_p3_routeds
    s_cmp_eq_u32 s30, s66
    s_cbranch_scc0 L_p3_noys
L_p3_routeds:
    s_add_u32 s40, s24, 0xa80800
    s_addc_u32 s41, s25, 0
    s_mov_b32 s42, 0x8000
    s_mov_b32 s43, 0x00020000
    s_mul_i32 s29, s70, 80
    s_lshr_b32 s29, s29, 6
    v_min_u32 v5, 1, v255
    v_add_u32 v5, s29, v5
    v_lshlrev_b32 v5, 7, v5
    s_mov_b32 s67, 200000
L_p3_fys:
    buffer_load_dword v10, v5, s[40:43], 0 offen sc1
    s_waitcnt vmcnt(0)
    v_cmp_ne_u32 vcc, s26, v10
    s_cbranch_vccz L_p3_fys_ok
    s_sleep 4
    s_sub_u32 s67, s67, 1
    s_cmp_lg_u32 s67, 0
    s_cbranch_scc1 L_p3_fys
L_p3_fys_ok:
    v_lshlrev_b32 v23, 4, v31
    s_mul_i32 s29, s70, 320
    v_add_u32 v23, s29, v23
    v_add_u32 v24, 2560, v23
    v_cmp_eq_u32 vcc, s63, v37
    v_cmp_eq_u32 s[30:31], s64, v37
    s_nop 0
    v_cndmask_b32 v25, v25, v23, vcc
    v_cndmask_b32 v25, v25, v24, s[30:31]
L_p3_noys:
    s_add_u32 s40, s24, 0xa4e700
    s_addc_u32 s41, s25, 0
    s_mov_b32 s42, 0x1400
    s_mov_b32 s43, 0x00020000
    buffer_load_dwordx4 v[204:207], v25, s[40:43], 0 offen offset:0 sc1
    buffer_load_dwordx4 v[208:211], v25, s[40:43], 0 offen offset:64 sc1
    buffer_load_dwordx4 v[212:215], v25, s[40:43], 0 offen offset:128 sc1
    buffer_load_dwordx4 v[216:219], v25, s[40:43], 0 offen offset:192 sc1
    buffer_load_dwordx4 v[220:223], v25, s[40:43], 0 offen offset:256 sc1
    v_cmp_eq_u32 vcc, s26, v20
    s_and_b32 s65, vcc_lo, 0xffff
    s_cmp_eq_u32 s65, 0xffff
    s_cbranch_scc1 L_p3_static
    s_mov_b32 s67, 200000
L_p3_f2:
    s_sleep 2
    buffer_load_dword v20, v16, s[48:51], 0 offen sc1
    s_waitcnt vmcnt(0)
    v_cmp_ne_u32 vcc, s26, v20
    s_cbranch_vccz L_p3_static
    s_sub_u32 s67, s67, 1
    s_cmp_lg_u32 s67, 0
    s_cbranch_scc1 L_p3_f2
L_p3_static:
    ds_read_b64_tr_b16 v[160:161], v14 offset:0
    ds_read_b64_tr_b16 v[162:163], v14 offset:1280
    ds_read_b64_tr_b16 v[164:165], v14 offset:32
    ds_read_b64_tr_b16 v[166:167], v14 offset:1312
    ds_read_b64_tr_b16 v[168:169], v14 offset:64
    ds_read_b64_tr_b16 v[170:171], v14 offset:1344
    ds_read_b64_tr_b16 v[172:173], v14 offset:96
    ds_read_b64_tr_b16 v[174:175], v14 offset:1376
    ds_read_b64_tr_b16 v[176:177], v14 offset:128
    ds_read_b64_tr_b16 v[178:179], v14 offset:1408
    s_add_u32 s29, s61, 0
    buffer_load_dwordx4 v[40:43], v17, s[44:47], s29 offen offset:0 sc1
    s_add_u32 s29, s61, 0
    buffer_load_dwordx4 v[44:47], v17, s[44:47], s29 offen offset:256 sc1
    s_add_u32 s29, s61, 2048
    buffer_load_dwordx4 v[48:51], v17, s[44:47], s29 offen offset:0 sc1
    s_add_u32 s29, s61, 2048
    buffer_load_dwordx4 v[52:55], v17, s[44:47], s29 offen offset:256 sc1
    s_add_u32 s29, s61, 4096
    buffer_load_dwordx4 v[56:59], v17, s[44:47], s29 offen offset:0 sc1
    s_add_u32 s29, s61, 4096
    buffer_load_dwordx4 v[60:63], v17, s[44:47], s29 offen offset:256 sc1
    s_add_u32 s29, s61, 6144
    buffer_load_dwordx4 v[64:67], v17, s[44:47], s29 offen offset:0 sc1
    s_add_u32 s29, s61, 6144
    buffer_load_dwordx4 v[68:71], v17, s[44:47], s29 offen offset:256 sc1
    s_add_u32 s29, s62, 0
    buffer_load_dwordx2 v[104:105], v18, s[32:35], s29 offen offset:0 sc1
    buffer_load_dwordx2 v[106:107], v18, s[32:35], s29 offen offset:256 sc1
    s_add_u32 s29, s62, 0
    buffer_load_dwordx2 v[108:109], v18, s[32:35], s29 offen offset:128 sc1
    buffer_load_dwordx2 v[110:111], v18, s[32:35], s29 offen offset:384 sc1
    s_add_u32 s29, s61, 8192
    buffer_load_dwordx4 v[72:75], v17, s[44:47], s29 offen offset:0 sc1
    s_add_u32 s29, s61, 8192
    buffer_load_dwordx4 v[76:79], v17, s[44:47], s29 offen offset:256 sc1
    s_add_u32 s29, s61, 10240
    buffer_load_dwordx4 v[80:83], v17, s[44:47], s29 offen offset:0 sc1
    s_add_u32 s29, s61, 10240
    buffer_load_dwordx4 v[84:87], v17, s[44:47], s29 offen offset:256 sc1
    s_add_u32 s29, s61, 12288
    buffer_load_dwordx4 v[88:91], v17, s[44:47], s29 offen offset:0 sc1
    s_add_u32 s29, s61, 12288
    buffer_load_dwordx4 v[92:95], v17, s[44:47], s29 offen offset:256 sc1
    s_add_u32 s29, s61, 14336
    buffer_load_dwordx4 v[96:99], v17, s[44:47], s29 offen offset:0 sc1
    s_add_u32 s29, s61, 14336
    buffer_load_dwordx4 v[100:103], v17, s[44:47], s29 offen offset:256 sc1
    s_add_u32 s29, s62, 2048
    buffer_load_dwordx2 v[112:113], v18, s[32:35], s29 offen offset:0 sc1
    buffer_load_dwordx2 v[114:115], v18, s[32:35], s29 offen offset:256 sc1
    s_add_u32 s29, s62, 2048
    buffer_load_dwordx2 v[116:117], v18, s[32:35], s29 offen offset:128 sc1
    buffer_load_dwordx2 v[118:119], v18, s[32:35], s29 offen offset:384 sc1
    s_waitcnt vmcnt(24)
    v_add_f32 v26, 1.0, v225
    v_mul_f32 v27, v224, v225
    v_lshlrev_b32 v8, 16, v228
    v_and_b32 v9, 0xffff0000, v228
    v_lshlrev_b32 v10, 16, v229
    v_and_b32 v11, 0xffff0000, v229
    v_fma_f32 v8, v8, v26, -v27
    v_fma_f32 v9, v9, v26, -v27
    v_fma_f32 v10, v10, v26, -v27
    v_fma_f32 v11, v11, v26, -v27
    v_add_f32 v204, v204, v8
    v_add_f32 v205, v205, v9
    v_add_f32 v206, v206, v10
    v_add_f32 v207, v207, v11
    v_lshlrev_b32 v8, 16, v230
    v_and_b32 v9, 0xffff0000, v230
    v_lshlrev_b32 v10, 16, v231
    v_and_b32 v11, 0xffff0000, v231
    v_fma_f32 v8, v8, v26, -v27
    v_fma_f32 v9, v9, v26, -v27
    v_fma_f32 v10, v10, v26, -v27
    v_fma_f32 v11, v11, v26, -v27
    v_add_f32 v208, v208, v8
    v_add_f32 v209, v209, v9
    v_add_f32 v210, v210, v10
    v_add_f32 v211, v211, v11
    v_lshlrev_b32 v8, 16, v232
    v_and_b32 v9, 0xffff0000, v232
    v_lshlrev_b32 v10, 16, v233
    v_and_b32 v11, 0xffff0000, v233
    v_fma_f32 v8, v8, v26, -v27
    v_fma_f32 v9, v9, v26, -v27
    v_fma_f32 v10, v10, v26, -v27
    v_fma_f32 v11, v11, v26, -v27
    v_add_f32 v212, v212, v8
    v_add_f32 v213, v213, v9
    v_add_f32 v214, v214, v10
    v_add_f32 v215, v215, v11
    v_lshlrev_b32 v8, 16, v234
    v_and_b32 v9, 0xffff0000, v234
    v_lshlrev_b32 v10, 16, v235
    v_and_b32 v11, 0xffff0000, v235
    v_fma_f32 v8, v8, v26, -v27
    v_fma_f32 v9, v9, v26, -v27
    v_fma_f32 v10, v10, v26, -v27
    v_fma_f32 v11, v11, v26, -v27
    v_add_f32 v216, v216, v8
    v_add_f32 v217, v217, v9
    v_add_f32 v218, v218, v10
    v_add_f32 v219, v219, v11
    v_lshlrev_b32 v8, 16, v236
    v_and_b32 v9, 0xffff0000, v236
    v_lshlrev_b32 v10, 16, v237
    v_and_b32 v11, 0xffff0000, v237
    v_fma_f32 v8, v8, v26, -v27
    v_fma_f32 v9, v9, v26, -v27
    v_fma_f32 v10, v10, v26, -v27
    v_fma_f32 v11, v11, v26, -v27
    v_add_f32 v220, v220, v8
    v_add_f32 v221, v221, v9
    v_add_f32 v222, v222, v10
    v_add_f32 v223, v223, v11
    ds_read_b64_tr_b16 v[180:181], v14 offset:6400
    ds_read_b64_tr_b16 v[182:183], v14 offset:7680
    ds_read_b64_tr_b16 v[184:185], v14 offset:6432
    ds_read_b64_tr_b16 v[186:187], v14 offset:7712
    ds_read_b64_tr_b16 v[188:189], v14 offset:6464
    ds_read_b64_tr_b16 v[190:191], v14 offset:7744
    ds_read_b64_tr_b16 v[192:193], v14 offset:6496
    ds_read_b64_tr_b16 v[194:195], v14 offset:7776
    ds_read_b64_tr_b16 v[196:197], v14 offset:6528
    ds_read_b64_tr_b16 v[198:199], v14 offset:7808
    s_waitcnt lgkmcnt(10)
    s_waitcnt vmcnt(22)
    v_mfma_f32_16x16x32_bf16 v[120:123], v[160:163], v[40:43], 0
    v_mfma_f32_16x16x32_bf16 v[140:143], v[160:163], v[44:47], 0
    v_mfma_f32_16x16x32_bf16 v[124:127], v[164:167], v[40:43], 0
    v_mfma_f32_16x16x32_bf16 v[144:147], v[164:167], v[44:47], 0
    v_mfma_f32_16x16x32_bf16 v[128:131], v[168:171], v[40:43], 0
    v_mfma_f32_16x16x32_bf16 v[148:151], v[168:171], v[44:47], 0
    v_mfma_f32_16x16x32_bf16 v[132:135], v[172:175], v[40:43], 0
    v_mfma_f32_16x16x32_bf16 v[152:155], v[172:175], v[44:47], 0
    v_mfma_f32_16x16x32_bf16 v[136:139], v[176:179], v[40:43], 0
    v_mfma_f32_16x16x32_bf16 v[156:159], v[176:179], v[44:47], 0
    ds_read_b64_tr_b16 v[160:161], v14 offset:12800
    ds_read_b64_tr_b16 v[162:163], v14 offset:14080
    ds_read_b64_tr_b16 v[164:165], v14 offset:12832
    ds_read_b64_tr_b16 v[166:167], v14 offset:14112
    ds_read_b64_tr_b16 v[168:169], v14 offset:12864
    ds_read_b64_tr_b16 v[170:171], v14 offset:14144
    ds_read_b64_tr_b16 v[172:173], v14 offset:12896
    ds_read_b64_tr_b16 v[174:175], v14 offset:14176
    ds_read_b64_tr_b16 v[176:177], v14 offset:12928
    ds_read_b64_tr_b16 v[178:179], v14 offset:14208
    s_waitcnt lgkmcnt(10)
    s_waitcnt vmcnt(20)
    v_mfma_f32_16x16x32_bf16 v[120:123], v[180:183], v[48:51], v[120:123]
    v_mfma_f32_16x16x32_bf16 v[140:143], v[180:183], v[52:55], v[140:143]
    v_mfma_f32_16x16x32_bf16 v[124:127], v[184:187], v[48:51], v[124:127]
    v_mfma_f32_16x16x32_bf16 v[144:147], v[184:187], v[52:55], v[144:147]
    v_mfma_f32_16x16x32_bf16 v[128:131], v[188:191], v[48:51], v[128:131]
    v_mfma_f32_16x16x32_bf16 v[148:151], v[188:191], v[52:55], v[148:151]
    v_mfma_f32_16x16x32_bf16 v[132:135], v[192:195], v[48:51], v[132:135]
    v_mfma_f32_16x16x32_bf16 v[152:155], v[192:195], v[52:55], v[152:155]
    v_mfma_f32_16x16x32_bf16 v[136:139], v[196:199], v[48:51], v[136:139]
    v_mfma_f32_16x16x32_bf16 v[156:159], v[196:199], v[52:55], v[156:159]
    ds_read_b64_tr_b16 v[180:181], v14 offset:19200
    ds_read_b64_tr_b16 v[182:183], v14 offset:20480
    ds_read_b64_tr_b16 v[184:185], v14 offset:19232
    ds_read_b64_tr_b16 v[186:187], v14 offset:20512
    ds_read_b64_tr_b16 v[188:189], v14 offset:19264
    ds_read_b64_tr_b16 v[190:191], v14 offset:20544
    ds_read_b64_tr_b16 v[192:193], v14 offset:19296
    ds_read_b64_tr_b16 v[194:195], v14 offset:20576
    ds_read_b64_tr_b16 v[196:197], v14 offset:19328
    ds_read_b64_tr_b16 v[198:199], v14 offset:20608
    s_waitcnt lgkmcnt(10)
    s_waitcnt vmcnt(18)
    v_mfma_f32_16x16x32_bf16 v[120:123], v[160:163], v[56:59], v[120:123]
    v_mfma_f32_16x16x32_bf16 v[140:143], v[160:163], v[60:63], v[140:143]
    v_mfma_f32_16x16x32_bf16 v[124:127], v[164:167], v[56:59], v[124:127]
    v_mfma_f32_16x16x32_bf16 v[144:147], v[164:167], v[60:63], v[144:147]
    v_mfma_f32_16x16x32_bf16 v[128:131], v[168:171], v[56:59], v[128:131]
    v_mfma_f32_16x16x32_bf16 v[148:151], v[168:171], v[60:63], v[148:151]
    v_mfma_f32_16x16x32_bf16 v[132:135], v[172:175], v[56:59], v[132:135]
    v_mfma_f32_16x16x32_bf16 v[152:155], v[172:175], v[60:63], v[152:155]
    v_mfma_f32_16x16x32_bf16 v[136:139], v[176:179], v[56:59], v[136:139]
    v_mfma_f32_16x16x32_bf16 v[156:159], v[176:179], v[60:63], v[156:159]
    ds_read_b64_tr_b16 v[160:161], v15 offset:0
    ds_read_b64_tr_b16 v[162:163], v15 offset:3200
    ds_read_b64_tr_b16 v[164:165], v15 offset:32
    ds_read_b64_tr_b16 v[166:167], v15 offset:3232
    ds_read_b64_tr_b16 v[168:169], v15 offset:64
    ds_read_b64_tr_b16 v[170:171], v15 offset:3264
    ds_read_b64_tr_b16 v[172:173], v15 offset:96
    ds_read_b64_tr_b16 v[174:175], v15 offset:3296
    ds_read_b64_tr_b16 v[176:177], v15 offset:128
    ds_read_b64_tr_b16 v[178:179], v15 offset:3328
    s_waitcnt lgkmcnt(10)
    s_waitcnt vmcnt(16)
    v_mfma_f32_16x16x32_bf16 v[120:123], v[180:183], v[64:67], v[120:123]
    v_mfma_f32_16x16x32_bf16 v[140:143], v[180:183], v[68:71], v[140:143]
    v_mfma_f32_16x16x32_bf16 v[124:127], v[184:187], v[64:67], v[124:127]
    v_mfma_f32_16x16x32_bf16 v[144:147], v[184:187], v[68:71], v[144:147]
    v_mfma_f32_16x16x32_bf16 v[128:131], v[188:191], v[64:67], v[128:131]
    v_mfma_f32_16x16x32_bf16 v[148:151], v[188:191], v[68:71], v[148:151]
    v_mfma_f32_16x16x32_bf16 v[132:135], v[192:195], v[64:67], v[132:135]
    v_mfma_f32_16x16x32_bf16 v[152:155], v[192:195], v[68:71], v[152:155]
    v_mfma_f32_16x16x32_bf16 v[136:139], v[196:199], v[64:67], v[136:139]
    v_mfma_f32_16x16x32_bf16 v[156:159], v[196:199], v[68:71], v[156:159]
    ds_read_b64_tr_b16 v[180:181], v14 offset:25600
    ds_read_b64_tr_b16 v[182:183], v14 offset:26880
    ds_read_b64_tr_b16 v[184:185], v14 offset:25632
    ds_read_b64_tr_b16 v[186:187], v14 offset:26912
    ds_read_b64_tr_b16 v[188:189], v14 offset:25664
    ds_read_b64_tr_b16 v[190:191], v14 offset:26944
    ds_read_b64_tr_b16 v[192:193], v14 offset:25696
    ds_read_b64_tr_b16 v[194:195], v14 offset:26976
    ds_read_b64_tr_b16 v[196:197], v14 offset:25728
    ds_read_b64_tr_b16 v[198:199], v14 offset:27008
    s_waitcnt lgkmcnt(10)
    s_waitcnt vmcnt(12)
    v_mfma_f32_16x16x32_bf16 v[120:123], v[160:163], v[104:107], v[120:123]
    v_mfma_f32_16x16x32_bf16 v[140:143], v[160:163], v[108:111], v[140:143]
    v_mfma_f32_16x16x32_bf16 v[124:127], v[164:167], v[104:107], v[124:127]
    v_mfma_f32_16x16x32_bf16 v[144:147], v[164:167], v[108:111], v[144:147]
    v_mfma_f32_16x16x32_bf16 v[128:131], v[168:171], v[104:107], v[128:131]
    v_mfma_f32_16x16x32_bf16 v[148:151], v[168:171], v[108:111], v[148:151]
    v_mfma_f32_16x16x32_bf16 v[132:135], v[172:175], v[104:107], v[132:135]
    v_mfma_f32_16x16x32_bf16 v[152:155], v[172:175], v[108:111], v[152:155]
    v_mfma_f32_16x16x32_bf16 v[136:139], v[176:179], v[104:107], v[136:139]
    v_mfma_f32_16x16x32_bf16 v[156:159], v[176:179], v[108:111], v[156:159]
    ds_read_b64_tr_b16 v[160:161], v14 offset:32000
    ds_read_b64_tr_b16 v[162:163], v14 offset:33280
    ds_read_b64_tr_b16 v[164:165], v14 offset:32032
    ds_read_b64_tr_b16 v[166:167], v14 offset:33312
    ds_read_b64_tr_b16 v[168:169], v14 offset:32064
    ds_read_b64_tr_b16 v[170:171], v14 offset:33344
    ds_read_b64_tr_b16 v[172:173], v14 offset:32096
    ds_read_b64_tr_b16 v[174:175], v14 offset:33376
    ds_read_b64_tr_b16 v[176:177], v14 offset:32128
    ds_read_b64_tr_b16 v[178:179], v14 offset:33408
    s_waitcnt lgkmcnt(10)
    s_waitcnt vmcnt(10)
    v_mfma_f32_16x16x32_bf16 v[120:123], v[180:183], v[72:75], v[120:123]
    v_mfma_f32_16x16x32_bf16 v[140:143], v[180:183], v[76:79], v[140:143]
    v_mfma_f32_16x16x32_bf16 v[124:127], v[184:187], v[72:75], v[124:127]
    v_mfma_f32_16x16x32_bf16 v[144:147], v[184:187], v[76:79], v[144:147]
    v_mfma_f32_16x16x32_bf16 v[128:131], v[188:191], v[72:75], v[128:131]
    v_mfma_f32_16x16x32_bf16 v[148:151], v[188:191], v[76:79], v[148:151]
    v_mfma_f32_16x16x32_bf16 v[132:135], v[192:195], v[72:75], v[132:135]
    v_mfma_f32_16x16x32_bf16 v[152:155], v[192:195], v[76:79], v[152:155]
    v_mfma_f32_16x16x32_bf16 v[136:139], v[196:199], v[72:75], v[136:139]
    v_mfma_f32_16x16x32_bf16 v[156:159], v[196:199], v[76:79], v[156:159]
    ds_read_b64_tr_b16 v[180:181], v14 offset:38400
    ds_read_b64_tr_b16 v[182:183], v14 offset:39680
    ds_read_b64_tr_b16 v[184:185], v14 offset:38432
    ds_read_b64_tr_b16 v[186:187], v14 offset:39712
    ds_read_b64_tr_b16 v[188:189], v14 offset:38464
    ds_read_b64_tr_b16 v[190:191], v14 offset:39744
    ds_read_b64_tr_b16 v[192:193], v14 offset:38496
    ds_read_b64_tr_b16 v[194:195], v14 offset:39776
    ds_read_b64_tr_b16 v[196:197], v14 offset:38528
    ds_read_b64_tr_b16 v[198:199], v14 offset:39808
    s_waitcnt lgkmcnt(10)
    s_waitcnt vmcnt(8)
    v_mfma_f32_16x16x32_bf16 v[120:123], v[160:163], v[80:83], v[120:123]
    v_mfma_f32_16x16x32_bf16 v[140:143], v[160:163], v[84:87], v[140:143]
    v_mfma_f32_16x16x32_bf16 v[124:127], v[164:167], v[80:83], v[124:127]
    v_mfma_f32_16x16x32_bf16 v[144:147], v[164:167], v[84:87], v[144:147]
    v_mfma_f32_16x16x32_bf16 v[128:131], v[168:171], v[80:83], v[128:131]
    v_mfma_f32_16x16x32_bf16 v[148:151], v[168:171], v[84:87], v[148:151]
    v_mfma_f32_16x16x32_bf16 v[132:135], v[172:175], v[80:83], v[132:135]
    v_mfma_f32_16x16x32_bf16 v[152:155], v[172:175], v[84:87], v[152:155]
    v_mfma_f32_16x16x32_bf16 v[136:139], v[176:179], v[80:83], v[136:139]
    v_mfma_f32_16x16x32_bf16 v[156:159], v[176:179], v[84:87], v[156:159]
    ds_read_b64_tr_b16 v[160:161], v14 offset:44800
    ds_read_b64_tr_b16 v[162:163], v14 offset:46080
    ds_read_b64_tr_b16 v[164:165], v14 offset:44832
    ds_read_b64_tr_b16 v[166:167], v14 offset:46112
    ds_read_b64_tr_b16 v[168:169], v14 offset:44864
    ds_read_b64_tr_b16 v[170:171], v14 offset:46144
    ds_read_b64_tr_b16 v[172:173], v14 offset:44896
    ds_read_b64_tr_b16 v[174:175], v14 offset:46176
    ds_read_b64_tr_b16 v[176:177], v14 offset:44928
    ds_read_b64_tr_b16 v[178:179], v14 offset:46208
    s_waitcnt lgkmcnt(10)
    s_waitcnt vmcnt(6)
    v_mfma_f32_16x16x32_bf16 v[120:123], v[180:183], v[88:91], v[120:123]
    v_mfma_f32_16x16x32_bf16 v[140:143], v[180:183], v[92:95], v[140:143]
    v_mfma_f32_16x16x32_bf16 v[124:127], v[184:187], v[88:91], v[124:127]
    v_mfma_f32_16x16x32_bf16 v[144:147], v[184:187], v[92:95], v[144:147]
    v_mfma_f32_16x16x32_bf16 v[128:131], v[188:191], v[88:91], v[128:131]
    v_mfma_f32_16x16x32_bf16 v[148:151], v[188:191], v[92:95], v[148:151]
    v_mfma_f32_16x16x32_bf16 v[132:135], v[192:195], v[88:91], v[132:135]
    v_mfma_f32_16x16x32_bf16 v[152:155], v[192:195], v[92:95], v[152:155]
    v_mfma_f32_16x16x32_bf16 v[136:139], v[196:199], v[88:91], v[136:139]
    v_mfma_f32_16x16x32_bf16 v[156:159], v[196:199], v[92:95], v[156:159]
    ds_read_b64_tr_b16 v[180:181], v15 offset:25600
    ds_read_b64_tr_b16 v[182:183], v15 offset:28800
    ds_read_b64_tr_b16 v[184:185], v15 offset:25632
    ds_read_b64_tr_b16 v[186:187], v15 offset:28832
    ds_read_b64_tr_b16 v[188:189], v15 offset:25664
    ds_read_b64_tr_b16 v[190:191], v15 offset:28864
    ds_read_b64_tr_b16 v[192:193], v15 offset:25696
    ds_read_b64_tr_b16 v[194:195], v15 offset:28896
    ds_read_b64_tr_b16 v[196:197], v15 offset:25728
    ds_read_b64_tr_b16 v[198:199], v15 offset:28928
    s_waitcnt lgkmcnt(10)
    s_waitcnt vmcnt(4)
    v_mfma_f32_16x16x32_bf16 v[120:123], v[160:163], v[96:99], v[120:123]
    v_mfma_f32_16x16x32_bf16 v[140:143], v[160:163], v[100:103], v[140:143]
    v_mfma_f32_16x16x32_bf16 v[124:127], v[164:167], v[96:99], v[124:127]
    v_mfma_f32_16x16x32_bf16 v[144:147], v[164:167], v[100:103], v[144:147]
    v_mfma_f32_16x16x32_bf16 v[128:131], v[168:171], v[96:99], v[128:131]
    v_mfma_f32_16x16x32_bf16 v[148:151], v[168:171], v[100:103], v[148:151]
    v_mfma_f32_16x16x32_bf16 v[132:135], v[172:175], v[96:99], v[132:135]
    v_mfma_f32_16x16x32_bf16 v[152:155], v[172:175], v[100:103], v[152:155]
    v_mfma_f32_16x16x32_bf16 v[136:139], v[176:179], v[96:99], v[136:139]
    v_mfma_f32_16x16x32_bf16 v[156:159], v[176:179], v[100:103], v[156:159]
    s_waitcnt lgkmcnt(0)
    s_waitcnt vmcnt(0)
    v_mfma_f32_16x16x32_bf16 v[120:123], v[180:183], v[112:115], v[120:123]
    v_mfma_f32_16x16x32_bf16 v[140:143], v[180:183], v[116:119], v[140:143]
    v_mfma_f32_16x16x32_bf16 v[124:127], v[184:187], v[112:115], v[124:127]
    v_mfma_f32_16x16x32_bf16 v[144:147], v[184:187], v[116:119], v[144:147]
    v_mfma_f32_16x16x32_bf16 v[128:131], v[188:191], v[112:115], v[128:131]
    v_mfma_f32_16x16x32_bf16 v[148:151], v[188:191], v[116:119], v[148:151]
    v_mfma_f32_16x16x32_bf16 v[132:135], v[192:195], v[112:115], v[132:135]
    v_mfma_f32_16x16x32_bf16 v[152:155], v[192:195], v[116:119], v[152:155]
    v_mfma_f32_16x16x32_bf16 v[136:139], v[196:199], v[112:115], v[136:139]
    v_mfma_f32_16x16x32_bf16 v[156:159], v[196:199], v[116:119], v[156:159]
    s_mov_b32 s48, s20
    s_mov_b32 s49, s21
    s_mov_b32 s50, 0x280000
    s_mov_b32 s51, 0x00020000
    s_mul_i32 s29, s3, 5120
    s_add_u32 s29, s29, 102400
    v_lshlrev_b32 v5, 4, v255
    v_add_u32 v6, s29, v5
    s_xor_b32 s30, s3, 2
    s_mul_i32 s30, s30, 5120
    s_add_u32 s30, s30, 102400
    v_add_u32 v7, s30, v5
    s_cmp_eq_u32 s59, 0
    s_cbranch_scc0 L_p3_kh1
    ds_write_b128 v6, v[140:143] offset:0
    ds_write_b128 v6, v[144:147] offset:1024
    ds_write_b128 v6, v[148:151] offset:2048
    ds_write_b128 v6, v[152:155] offset:3072
    ds_write_b128 v6, v[156:159] offset:4096
    v_add_f32 v204, v204, v120
    v_add_f32 v205, v205, v121
    v_add_f32 v206, v206, v122
    v_add_f32 v207, v207, v123
    v_add_f32 v208, v208, v124
    v_add_f32 v209, v209, v125
    v_add_f32 v210, v210, v126
    v_add_f32 v211, v211, v127
    v_add_f32 v212, v212, v128
    v_add_f32 v213, v213, v129
    v_add_f32 v214, v214, v130
    v_add_f32 v215, v215, v131
    v_add_f32 v216, v216, v132
    v_add_f32 v217, v217, v133
    v_add_f32 v218, v218, v134
    v_add_f32 v219, v219, v135
    v_add_f32 v220, v220, v136
    v_add_f32 v221, v221, v137
    v_add_f32 v222, v222, v138
    v_add_f32 v223, v223, v139
    s_waitcnt lgkmcnt(0)
    s_barrier
    ds_read_b128 v[160:163], v7 offset:0
    ds_read_b128 v[164:167], v7 offset:1024
    ds_read_b128 v[168:171], v7 offset:2048
    ds_read_b128 v[172:175], v7 offset:3072
    ds_read_b128 v[176:179], v7 offset:4096
    s_branch L_p3_red
L_p3_kh1:
    ds_write_b128 v6, v[120:123] offset:0
    ds_write_b128 v6, v[124:127] offset:1024
    ds_write_b128 v6, v[128:131] offset:2048
    ds_write_b128 v6, v[132:135] offset:3072
    ds_write_b128 v6, v[136:139] offset:4096
    v_add_f32 v204, v204, v140
    v_add_f32 v205, v205, v141
    v_add_f32 v206, v206, v142
    v_add_f32 v207, v207, v143
    v_add_f32 v208, v208, v144
    v_add_f32 v209, v209, v145
    v_add_f32 v210, v210, v146
    v_add_f32 v211, v211, v147
    v_add_f32 v212, v212, v148
    v_add_f32 v213, v213, v149
    v_add_f32 v214, v214, v150
    v_add_f32 v215, v215, v151
    v_add_f32 v216, v216, v152
    v_add_f32 v217, v217, v153
    v_add_f32 v218, v218, v154
    v_add_f32 v219, v219, v155
    v_add_f32 v220, v220, v156
    v_add_f32 v221, v221, v157
    v_add_f32 v222, v222, v158
    v_add_f32 v223, v223, v159
    s_waitcnt lgkmcnt(0)
    s_barrier
    ds_read_b128 v[160:163], v7 offset:0
    ds_read_b128 v[164:167], v7 offset:1024
    ds_read_b128 v[168:171], v7 offset:2048
    ds_read_b128 v[172:175], v7 offset:3072
    ds_read_b128 v[176:179], v7 offset:4096
L_p3_red:
    s_waitcnt lgkmcnt(4)
    v_add_f32 v160, v160, v204
    v_add_f32 v161, v161, v205
    v_add_f32 v162, v162, v206
    v_add_f32 v163, v163, v207
    v_cvt_pk_bf16_f32 v160, v160, v161
    v_cvt_pk_bf16_f32 v161, v162, v163
    buffer_store_dwordx2 v[160:161], v29, s[48:51], 0 offen offset:0
    s_waitcnt lgkmcnt(3)
    v_add_f32 v164, v164, v208
    v_add_f32 v165, v165, v209
    v_add_f32 v166, v166, v210
    v_add_f32 v167, v167, v211
    v_cvt_pk_bf16_f32 v164, v164, v165
    v_cvt_pk_bf16_f32 v165, v166, v167
    buffer_store_dwordx2 v[164:165], v29, s[48:51], 0 offen offset:32
    s_waitcnt lgkmcnt(2)
    v_add_f32 v168, v168, v212
    v_add_f32 v169, v169, v213
    v_add_f32 v170, v170, v214
    v_add_f32 v171, v171, v215
    v_cvt_pk_bf16_f32 v168, v168, v169
    v_cvt_pk_bf16_f32 v169, v170, v171
    buffer_store_dwordx2 v[168:169], v29, s[48:51], 0 offen offset:64
    s_waitcnt lgkmcnt(1)
    v_add_f32 v172, v172, v216
    v_add_f32 v173, v173, v217
    v_add_f32 v174, v174, v218
    v_add_f32 v175, v175, v219
    v_cvt_pk_bf16_f32 v172, v172, v173
    v_cvt_pk_bf16_f32 v173, v174, v175
    buffer_store_dwordx2 v[172:173], v29, s[48:51], 0 offen offset:96
    s_waitcnt lgkmcnt(0)
    v_add_f32 v176, v176, v220
    v_add_f32 v177, v177, v221
    v_add_f32 v178, v178, v222
    v_add_f32 v179, v179, v223
    v_cvt_pk_bf16_f32 v176, v176, v177
    v_cvt_pk_bf16_f32 v177, v178, v179
    buffer_store_dwordx2 v[176:177], v29, s[48:51], 0 offen offset:128
    s_waitcnt vmcnt(0)
    s_endpgm
L_p2_fallback:
    s_mov_b32 s72, 1
    s_waitcnt vmcnt(0)
    s_add_u32 s36, s24, 0x280200
    s_addc_u32 s37, s25, 0
    s_mov_b32 s38, 0x280000
    s_mov_b32 s39, 0x00020000
    s_add_u32 s40, s24, 0x500300
    s_addc_u32 s41, s25, 0
    s_mov_b32 s42, 0x284000
    s_mov_b32 s43, 0x00020000
    s_lshr_b32 s29, s3, 1
    s_lshl_b32 s58, s29, 14
    s_add_u32 s58, s58, s63
    s_mul_i32 s60, s29, 1318912
    s_mov_b32 s59, 32
    v_mov_b32 v244, 0xff800000
    v_mov_b32 v245, 0xff800000
    v_mov_b32 v246, 0xff800000
    v_mov_b32 v247, 0xff800000
L_p2_fb_max:
    buffer_load_dwordx4 v[184:187], v2, s[36:39], s58 offen sc1
    buffer_load_dwordx2 v[196:197], v3, s[36:39], s58 offen sc1
    s_waitcnt vmcnt(0)
    v_mfma_f32_32x32x4_2b_bf16 v[104:135], v[196:197], v[24:25], 0
    s_nop 15
    s_nop 3
    v_mfma_f32_32x32x16_bf16 v[104:119], v[184:187], v[8:11], v[104:119]
    v_mfma_f32_32x32x16_bf16 v[120:135], v[184:187], v[12:15], v[120:135]
    s_nop 7
    s_nop 7
    v_max3_f32 v244, v104, v105, v244
    v_max3_f32 v244, v106, v107, v244
    v_max3_f32 v244, v108, v109, v244
    v_max3_f32 v244, v110, v111, v244
    v_max3_f32 v244, v112, v113, v244
    v_max3_f32 v244, v114, v115, v244
    v_max3_f32 v244, v116, v117, v244
    v_max3_f32 v244, v118, v119, v244
    v_max3_f32 v245, v120, v121, v245
    v_max3_f32 v245, v122, v123, v245
    v_max3_f32 v245, v124, v125, v245
    v_max3_f32 v245, v126, v127, v245
    v_max3_f32 v245, v128, v129, v245
    v_max3_f32 v245, v130, v131, v245
    v_max3_f32 v245, v132, v133, v245
    v_max3_f32 v245, v134, v135, v245
    s_nop 7
    v_mfma_f32_32x32x4_2b_bf16 v[104:135], v[196:197], v[26:27], 0
    s_nop 15
    s_nop 3
    v_mfma_f32_32x32x16_bf16 v[104:119], v[184:187], v[16:19], v[104:119]
    v_mfma_f32_32x32x16_bf16 v[120:135], v[184:187], v[20:23], v[120:135]
    s_nop 7
    s_nop 7
    v_max3_f32 v246, v104, v105, v246
    v_max3_f32 v246, v106, v107, v246
    v_max3_f32 v246, v108, v109, v246
    v_max3_f32 v246, v110, v111, v246
    v_max3_f32 v246, v112, v113, v246
    v_max3_f32 v246, v114, v115, v246
    v_max3_f32 v246, v116, v117, v246
    v_max3_f32 v246, v118, v119, v246
    v_max3_f32 v247, v120, v121, v247
    v_max3_f32 v247, v122, v123, v247
    v_max3_f32 v247, v124, v125, v247
    v_max3_f32 v247, v126, v127, v247
    v_max3_f32 v247, v128, v129, v247
    v_max3_f32 v247, v130, v131, v247
    v_max3_f32 v247, v132, v133, v247
    v_max3_f32 v247, v134, v135, v247
    s_nop 7
    s_add_u32 s58, s58, 512
    s_sub_u32 s59, s59, 1
    s_cmp_lg_u32 s59, 0
    s_cbranch_scc1 L_p2_fb_max
    v_mov_b32 v248, v244
    v_mov_b32 v249, v244
    s_nop 1
    v_permlane32_swap_b32 v248, v249
    s_nop 1
    v_max3_f32 v244, v244, v248, v249
    v_mov_b32 v248, v245
    v_mov_b32 v249, v245
    s_nop 1
    v_permlane32_swap_b32 v248, v249
    s_nop 1
    v_max3_f32 v245, v245, v248, v249
    v_mov_b32 v248, v246
    v_mov_b32 v249, v246
    s_nop 1
    v_permlane32_swap_b32 v248, v249
    s_nop 1
    v_max3_f32 v246, v246, v248, v249
    v_mov_b32 v248, v247
    v_mov_b32 v249, v247
    s_nop 1
    v_permlane32_swap_b32 v248, v249
    s_nop 1
    v_max3_f32 v247, v247, v248, v249
    s_barrier
    ds_write_b128 v0, v[244:247]
    s_waitcnt lgkmcnt(0)
    s_barrier
    ds_read_b128 v[248:251], v6
    s_waitcnt lgkmcnt(0)
    v_max_f32 v244, v244, v248
    v_max_f32 v245, v245, v249
    v_max_f32 v246, v246, v250
    v_max_f32 v247, v247, v251
    s_barrier
    s_lshr_b32 s29, s3, 1
    s_lshl_b32 s58, s29, 14
    s_add_u32 s58, s58, s63
    s_mul_i32 s60, s29, 1318912
    s_mov_b32 s59, 32
    v_mov_b32 v40, 0
    v_mov_b32 v41, 0
    v_mov_b32 v42, 0
    v_mov_b32 v43, 0
    v_mov_b32 v44, 0
    v_mov_b32 v45, 0
    v_mov_b32 v46, 0
    v_mov_b32 v47, 0
    v_mov_b32 v48, 0
    v_mov_b32 v49, 0
    v_mov_b32 v50, 0
    v_mov_b32 v51, 0
    v_mov_b32 v52, 0
    v_mov_b32 v53, 0
    v_mov_b32 v54, 0
    v_mov_b32 v55, 0
    v_mov_b32 v56, 0
    v_mov_b32 v57, 0
    v_mov_b32 v58, 0
    v_mov_b32 v59, 0
    v_mov_b32 v60, 0
    v_mov_b32 v61, 0
    v_mov_b32 v62, 0
    v_mov_b32 v63, 0
    v_mov_b32 v64, 0
    v_mov_b32 v65, 0
    v_mov_b32 v66, 0
    v_mov_b32 v67, 0
    v_mov_b32 v68, 0
    v_mov_b32 v69, 0
    v_mov_b32 v70, 0
    v_mov_b32 v71, 0
    v_mov_b32 v72, 0
    v_mov_b32 v73, 0
    v_mov_b32 v74, 0
    v_mov_b32 v75, 0
    v_mov_b32 v76, 0
    v_mov_b32 v77, 0
    v_mov_b32 v78, 0
    v_mov_b32 v79, 0
    v_mov_b32 v80, 0
    v_mov_b32 v81, 0
    v_mov_b32 v82, 0
    v_mov_b32 v83, 0
    v_mov_b32 v84, 0
    v_mov_b32 v85, 0
    v_mov_b32 v86, 0
    v_mov_b32 v87, 0
    v_mov_b32 v88, 0
    v_mov_b32 v89, 0
    v_mov_b32 v90, 0
    v_mov_b32 v91, 0
    v_mov_b32 v92, 0
    v_mov_b32 v93, 0
    v_mov_b32 v94, 0
    v_mov_b32 v95, 0
    v_mov_b32 v96, 0
    v_mov_b32 v97, 0
    v_mov_b32 v98, 0
    v_mov_b32 v99, 0
    v_mov_b32 v100, 0
    v_mov_b32 v101, 0
    v_mov_b32 v102, 0
    v_mov_b32 v103, 0
L_p2_fb_sum:
    buffer_load_dwordx4 v[184:187], v2, s[36:39], s58 offen sc1
    buffer_load_dwordx2 v[196:197], v3, s[36:39], s58 offen sc1
    buffer_load_dwordx4 v[188:191], v4, s[40:43], s60 offen sc1
    buffer_load_dwordx4 v[192:195], v5, s[40:43], s60 offen sc1
    s_waitcnt vmcnt(0)
    v_sub_f32 v104, 0, v244
    v_sub_f32 v105, 0, v244
    v_sub_f32 v106, 0, v244
    v_sub_f32 v107, 0, v244
    v_sub_f32 v108, 0, v244
    v_sub_f32 v109, 0, v244
    v_sub_f32 v110, 0, v244
    v_sub_f32 v111, 0, v244
    v_sub_f32 v112, 0, v244
    v_sub_f32 v113, 0, v244
    v_sub_f32 v114, 0, v244
    v_sub_f32 v115, 0, v244
    v_sub_f32 v116, 0, v244
    v_sub_f32 v117, 0, v244
    v_sub_f32 v118, 0, v244
    v_sub_f32 v119, 0, v244
    v_sub_f32 v120, 0, v245
    v_sub_f32 v121, 0, v245
    v_sub_f32 v122, 0, v245
    v_sub_f32 v123, 0, v245
    v_sub_f32 v124, 0, v245
    v_sub_f32 v125, 0, v245
    v_sub_f32 v126, 0, v245
    v_sub_f32 v127, 0, v245
    v_sub_f32 v128, 0, v245
    v_sub_f32 v129, 0, v245
    v_sub_f32 v130, 0, v245
    v_sub_f32 v131, 0, v245
    v_sub_f32 v132, 0, v245
    v_sub_f32 v133, 0, v245
    v_sub_f32 v134, 0, v245
    v_sub_f32 v135, 0, v245
    s_nop 1
    v_mfma_f32_32x32x4_2b_bf16 v[104:135], v[196:197], v[24:25], v[104:135]
    s_nop 15
    s_nop 3
    v_mfma_f32_32x32x16_bf16 v[104:119], v[184:187], v[8:11], v[104:119]
    v_mfma_f32_32x32x16_bf16 v[120:135], v[184:187], v[12:15], v[120:135]
    s_nop 7
    s_nop 7
    v_exp_f32 v104, v104
    v_exp_f32 v105, v105
    v_exp_f32 v106, v106
    v_exp_f32 v107, v107
    v_cvt_pk_bf16_f32 v168, v104, v105
    v_cvt_pk_bf16_f32 v169, v106, v107
    v_exp_f32 v108, v108
    v_exp_f32 v109, v109
    v_exp_f32 v110, v110
    v_exp_f32 v111, v111
    v_cvt_pk_bf16_f32 v170, v108, v109
    v_cvt_pk_bf16_f32 v171, v110, v111
    v_exp_f32 v112, v112
    v_exp_f32 v113, v113
    v_exp_f32 v114, v114
    v_exp_f32 v115, v115
    v_cvt_pk_bf16_f32 v172, v112, v113
    v_cvt_pk_bf16_f32 v173, v114, v115
    v_exp_f32 v116, v116
    v_exp_f32 v117, v117
    v_exp_f32 v118, v118
    v_exp_f32 v119, v119
    v_cvt_pk_bf16_f32 v174, v116, v117
    v_cvt_pk_bf16_f32 v175, v118, v119
    v_exp_f32 v120, v120
    v_exp_f32 v121, v121
    v_exp_f32 v122, v122
    v_exp_f32 v123, v123
    v_cvt_pk_bf16_f32 v176, v120, v121
    v_cvt_pk_bf16_f32 v177, v122, v123
    v_exp_f32 v124, v124
    v_exp_f32 v125, v125
    v_exp_f32 v126, v126
    v_exp_f32 v127, v127
    v_cvt_pk_bf16_f32 v178, v124, v125
    v_cvt_pk_bf16_f32 v179, v126, v127
    v_exp_f32 v128, v128
    v_exp_f32 v129, v129
    v_exp_f32 v130, v130
    v_exp_f32 v131, v131
    v_cvt_pk_bf16_f32 v180, v128, v129
    v_cvt_pk_bf16_f32 v181, v130, v131
    v_exp_f32 v132, v132
    v_exp_f32 v133, v133
    v_exp_f32 v134, v134
    v_exp_f32 v135, v135
    v_cvt_pk_bf16_f32 v182, v132, v133
    v_cvt_pk_bf16_f32 v183, v134, v135
    s_nop 1
    v_mfma_f32_32x32x16_bf16 v[40:55], v[188:191], v[168:171], v[40:55]
    v_mfma_f32_32x32x16_bf16 v[40:55], v[192:195], v[172:175], v[40:55]
    v_mfma_f32_32x32x16_bf16 v[56:71], v[188:191], v[176:179], v[56:71]
    v_mfma_f32_32x32x16_bf16 v[56:71], v[192:195], v[180:183], v[56:71]
    s_nop 7
    v_sub_f32 v104, 0, v246
    v_sub_f32 v105, 0, v246
    v_sub_f32 v106, 0, v246
    v_sub_f32 v107, 0, v246
    v_sub_f32 v108, 0, v246
    v_sub_f32 v109, 0, v246
    v_sub_f32 v110, 0, v246
    v_sub_f32 v111, 0, v246
    v_sub_f32 v112, 0, v246
    v_sub_f32 v113, 0, v246
    v_sub_f32 v114, 0, v246
    v_sub_f32 v115, 0, v246
    v_sub_f32 v116, 0, v246
    v_sub_f32 v117, 0, v246
    v_sub_f32 v118, 0, v246
    v_sub_f32 v119, 0, v246
    v_sub_f32 v120, 0, v247
    v_sub_f32 v121, 0, v247
    v_sub_f32 v122, 0, v247
    v_sub_f32 v123, 0, v247
    v_sub_f32 v124, 0, v247
    v_sub_f32 v125, 0, v247
    v_sub_f32 v126, 0, v247
    v_sub_f32 v127, 0, v247
    v_sub_f32 v128, 0, v247
    v_sub_f32 v129, 0, v247
    v_sub_f32 v130, 0, v247
    v_sub_f32 v131, 0, v247
    v_sub_f32 v132, 0, v247
    v_sub_f32 v133, 0, v247
    v_sub_f32 v134, 0, v247
    v_sub_f32 v135, 0, v247
    s_nop 1
    v_mfma_f32_32x32x4_2b_bf16 v[104:135], v[196:197], v[26:27], v[104:135]
    s_nop 15
    s_nop 3
    v_mfma_f32_32x32x16_bf16 v[104:119], v[184:187], v[16:19], v[104:119]
    v_mfma_f32_32x32x16_bf16 v[120:135], v[184:187], v[20:23], v[120:135]
    s_nop 7
    s_nop 7
    v_exp_f32 v104, v104
    v_exp_f32 v105, v105
    v_exp_f32 v106, v106
    v_exp_f32 v107, v107
    v_cvt_pk_bf16_f32 v168, v104, v105
    v_cvt_pk_bf16_f32 v169, v106, v107
    v_exp_f32 v108, v108
    v_exp_f32 v109, v109
    v_exp_f32 v110, v110
    v_exp_f32 v111, v111
    v_cvt_pk_bf16_f32 v170, v108, v109
    v_cvt_pk_bf16_f32 v171, v110, v111
    v_exp_f32 v112, v112
    v_exp_f32 v113, v113
    v_exp_f32 v114, v114
    v_exp_f32 v115, v115
    v_cvt_pk_bf16_f32 v172, v112, v113
    v_cvt_pk_bf16_f32 v173, v114, v115
    v_exp_f32 v116, v116
    v_exp_f32 v117, v117
    v_exp_f32 v118, v118
    v_exp_f32 v119, v119
    v_cvt_pk_bf16_f32 v174, v116, v117
    v_cvt_pk_bf16_f32 v175, v118, v119
    v_exp_f32 v120, v120
    v_exp_f32 v121, v121
    v_exp_f32 v122, v122
    v_exp_f32 v123, v123
    v_cvt_pk_bf16_f32 v176, v120, v121
    v_cvt_pk_bf16_f32 v177, v122, v123
    v_exp_f32 v124, v124
    v_exp_f32 v125, v125
    v_exp_f32 v126, v126
    v_exp_f32 v127, v127
    v_cvt_pk_bf16_f32 v178, v124, v125
    v_cvt_pk_bf16_f32 v179, v126, v127
    v_exp_f32 v128, v128
    v_exp_f32 v129, v129
    v_exp_f32 v130, v130
    v_exp_f32 v131, v131
    v_cvt_pk_bf16_f32 v180, v128, v129
    v_cvt_pk_bf16_f32 v181, v130, v131
    v_exp_f32 v132, v132
    v_exp_f32 v133, v133
    v_exp_f32 v134, v134
    v_exp_f32 v135, v135
    v_cvt_pk_bf16_f32 v182, v132, v133
    v_cvt_pk_bf16_f32 v183, v134, v135
    s_nop 1
    v_mfma_f32_32x32x16_bf16 v[72:87], v[188:191], v[168:171], v[72:87]
    v_mfma_f32_32x32x16_bf16 v[72:87], v[192:195], v[172:175], v[72:87]
    v_mfma_f32_32x32x16_bf16 v[88:103], v[188:191], v[176:179], v[88:103]
    v_mfma_f32_32x32x16_bf16 v[88:103], v[192:195], v[180:183], v[88:103]
    s_nop 7
    s_add_u32 s58, s58, 512
    s_add_u32 s60, s60, 41216
    s_sub_u32 s59, s59, 1
    s_cmp_lg_u32 s59, 0
    s_cbranch_scc1 L_p2_fb_sum
    s_nop 7
    s_nop 3
    s_branch L_p2_xch
L_helper:
    s_cmp_eq_u32 s3, 4
    s_cbranch_scc0 L_h_w
    s_add_u32 s36, s24, 0xa50800
    s_addc_u32 s37, s25, 0
    s_mov_b32 s38, 0x8000
    s_mov_b32 s39, 0x00020000
    s_lshl_b32 s29, s27, 11
    v_lshlrev_b32 v22, 4, v255
    v_add_u32 v22, s29, v22
    buffer_load_dwordx4 v[32:35], v22, s[36:39], 0 offen sc1
    buffer_load_dwordx4 v[36:39], v22, s[36:39], 0 offen offset:1024 sc1
    s_waitcnt vmcnt(18)
    s_barrier
    s_waitcnt vmcnt(2)
    s_barrier
    s_mov_b32 s67, 200000
    s_waitcnt vmcnt(0)
    s_branch L_gx_test
L_gx_check:
    s_waitcnt vmcnt(0)
L_gx_test:
    v_cmp_ne_u32 vcc, s26, v33
    v_cmp_ne_u32 s[30:31], s26, v35
    s_or_b64 vcc, vcc, s[30:31]
    v_cmp_ne_u32 s[30:31], s26, v37
    s_or_b64 vcc, vcc, s[30:31]
    v_cmp_ne_u32 s[30:31], s26, v39
    s_or_b64 vcc, vcc, s[30:31]
    s_cbranch_vccz L_gx_ok
    s_sleep 4
    s_add_u32 s36, s24, 0xa50800
    s_addc_u32 s37, s25, 0
    s_mov_b32 s38, 0x8000
    s_mov_b32 s39, 0x00020000
    s_lshl_b32 s29, s27, 11
    v_lshlrev_b32 v22, 4, v255
    v_add_u32 v22, s29, v22
    buffer_load_dwordx4 v[32:35], v22, s[36:39], 0 offen sc1
    buffer_load_dwordx4 v[36:39], v22, s[36:39], 0 offen offset:1024 sc1
    s_sub_u32 s67, s67, 1
    s_cmp_lg_u32 s67, 0
    s_cbranch_scc1 L_gx_check
    s_waitcnt vmcnt(0)
L_gx_ok:
    v_mul_f32 v32, v32, v34
    v_mul_f32 v36, v36, v38
    v_sub_f32 v32, 0, v32
    v_sub_f32 v36, 0, v36
    v_lshlrev_b32 v22, 2, v255
    v_add_u32 v22, 162304, v22
    ds_write_b32 v22, v34
    ds_write_b32 v22, v38 offset:256
    ds_write_b32 v22, v32 offset:512
    ds_write_b32 v22, v36 offset:768
    s_waitcnt lgkmcnt(0)
    s_barrier
    s_branch L_h_bf
L_h_w:
    s_add_u32 s36, s24, 0xa0c600
    s_addc_u32 s37, s25, 0
    s_mov_b32 s38, 0x40000
    s_mov_b32 s39, 0x00020000
    s_lshl_b32 s58, s28, 14
    v_lshlrev_b32 v22, 4, v255
    s_mov_b32 s59, s58
    buffer_load_dwordx4 v[32:35], v22, s[36:39], s59 offen sc1
    s_add_u32 s59, s59, 1024
    buffer_load_dwordx4 v[36:39], v22, s[36:39], s59 offen sc1
    s_add_u32 s59, s59, 1024
    buffer_load_dwordx4 v[40:43], v22, s[36:39], s59 offen sc1
    s_add_u32 s59, s59, 1024
    buffer_load_dwordx4 v[44:47], v22, s[36:39], s59 offen sc1
    s_add_u32 s59, s59, 1024
    buffer_load_dwordx4 v[48:51], v22, s[36:39], s59 offen sc1
    s_add_u32 s59, s59, 1024
    buffer_load_dwordx4 v[52:55], v22, s[36:39], s59 offen sc1
    s_add_u32 s59, s59, 1024
    buffer_load_dwordx4 v[56:59], v22, s[36:39], s59 offen sc1
    s_add_u32 s59, s59, 1024
    buffer_load_dwordx4 v[60:63], v22, s[36:39], s59 offen sc1
    s_add_u32 s59, s59, 1024
    buffer_load_dwordx4 v[64:67], v22, s[36:39], s59 offen sc1
    s_add_u32 s59, s59, 1024
    buffer_load_dwordx4 v[68:71], v22, s[36:39], s59 offen sc1
    s_add_u32 s59, s59, 1024
    buffer_load_dwordx4 v[72:75], v22, s[36:39], s59 offen sc1
    s_add_u32 s59, s59, 1024
    buffer_load_dwordx4 v[76:79], v22, s[36:39], s59 offen sc1
    s_add_u32 s59, s59, 1024
    buffer_load_dwordx4 v[80:83], v22, s[36:39], s59 offen sc1
    s_add_u32 s59, s59, 1024
    buffer_load_dwordx4 v[84:87], v22, s[36:39], s59 offen sc1
    s_add_u32 s59, s59, 1024
    buffer_load_dwordx4 v[88:91], v22, s[36:39], s59 offen sc1
    s_add_u32 s59, s59, 1024
    buffer_load_dwordx4 v[92:95], v22, s[36:39], s59 offen sc1
    s_waitcnt vmcnt(32)
    s_barrier
    s_cmp_ge_u32 s2, 240
    s_cbranch_scc1 L_w_nomoe
    s_mul_i32 s68, s2, 205
    s_lshr_b32 s68, s68, 11
    s_mul_i32 s29, s68, 10
    s_sub_u32 s69, s2, s29
    s_mov_b32 s40, s14
    s_mov_b32 s41, s15
    s_mov_b32 s42, 0x1e0000
    s_mov_b32 s43, 0x00020000
    s_mov_b32 s44, s16
    s_mov_b32 s45, s17
    s_mov_b32 s46, 0x1e0000
    s_mov_b32 s47, 0x00020000
    s_mov_b32 s48, s18
    s_mov_b32 s49, s19
    s_mov_b32 s50, 0x1e0000
    s_mov_b32 s51, 0x00020000
    v_lshrrev_b32 v3, 3, v255
    v_and_b32 v4, 7, v255
    v_mul_u32_u24 v5, 3072, v3
    v_lshl_add_u32 v5, v4, 4, v5
    v_mul_u32_u24 v6, 1280, v3
    v_lshl_add_u32 v6, v4, 4, v6
    s_mul_i32 s62, s69, 196608
    s_lshl_b32 s29, s68, 7
    s_add_u32 s62, s62, s29
    s_mul_i32 s63, s68, 81920
    s_lshl_b32 s29, s69, 7
    s_add_u32 s63, s63, s29
    s_mov_b32 m0, 131072
    s_add_u32 s64, s62, 0
    buffer_load_dwordx4 v5, s[40:43], s64 offen lds
    s_mov_b32 m0, 139264
    s_add_u32 s64, s62, 0
    buffer_load_dwordx4 v5, s[44:47], s64 offen lds
    s_mov_b32 m0, 132096
    s_add_u32 s64, s62, 24576
    buffer_load_dwordx4 v5, s[40:43], s64 offen lds
    s_mov_b32 m0, 140288
    s_add_u32 s64, s62, 24576
    buffer_load_dwordx4 v5, s[44:47], s64 offen lds
    s_mov_b32 m0, 133120
    s_add_u32 s64, s62, 49152
    buffer_load_dwordx4 v5, s[40:43], s64 offen lds
    s_mov_b32 m0, 141312
    s_add_u32 s64, s62, 49152
    buffer_load_dwordx4 v5, s[44:47], s64 offen lds
    s_mov_b32 m0, 134144
    s_add_u32 s64, s62, 73728
    buffer_load_dwordx4 v5, s[40:43], s64 offen lds
    s_mov_b32 m0, 142336
    s_add_u32 s64, s62, 73728
    buffer_load_dwordx4 v5, s[44:47], s64 offen lds
    s_mov_b32 m0, 135168
    s_add_u32 s64, s62, 98304
    buffer_load_dwordx4 v5, s[40:43], s64 offen lds
    s_mov_b32 m0, 143360
    s_add_u32 s64, s62, 98304
    buffer_load_dwordx4 v5, s[44:47], s64 offen lds
    s_mov_b32 m0, 136192
    s_add_u32 s64, s62, 122880
    buffer_load_dwordx4 v5, s[40:43], s64 offen lds
    s_mov_b32 m0, 144384
    s_add_u32 s64, s62, 122880
    buffer_load_dwordx4 v5, s[44:47], s64 offen lds
    s_mov_b32 m0, 137216
    s_add_u32 s64, s62, 147456
    buffer_load_dwordx4 v5, s[40:43], s64 offen lds
    s_mov_b32 m0, 145408
    s_add_u32 s64, s62, 147456
    buffer_load_dwordx4 v5, s[44:47], s64 offen lds
    s_mov_b32 m0, 138240
    s_add_u32 s64, s62, 172032
    buffer_load_dwordx4 v5, s[40:43], s64 offen lds
    s_mov_b32 m0, 146432
    s_add_u32 s64, s62, 172032
    buffer_load_dwordx4 v5, s[44:47], s64 offen lds
    s_mov_b32 m0, 147456
    s_add_u32 s64, s63, 0
    buffer_load_dwordx4 v6, s[48:51], s64 offen lds
    s_mov_b32 m0, 148480
    s_add_u32 s64, s63, 10240
    buffer_load_dwordx4 v6, s[48:51], s64 offen lds
    s_mov_b32 m0, 149504
    s_add_u32 s64, s63, 20480
    buffer_load_dwordx4 v6, s[48:51], s64 offen lds
    s_mov_b32 m0, 150528
    s_add_u32 s64, s63, 30720
    buffer_load_dwordx4 v6, s[48:51], s64 offen lds
    s_mov_b32 m0, 151552
    s_add_u32 s64, s63, 40960
    buffer_load_dwordx4 v6, s[48:51], s64 offen lds
    s_mov_b32 m0, 152576
    s_add_u32 s64, s63, 51200
    buffer_load_dwordx4 v6, s[48:51], s64 offen lds
    s_mov_b32 m0, 153600
    s_add_u32 s64, s63, 61440
    buffer_load_dwordx4 v6, s[48:51], s64 offen lds
    s_mov_b32 m0, 154624
    s_add_u32 s64, s63, 71680
    buffer_load_dwordx4 v6, s[48:51], s64 offen lds
    s_branch L_w_moe
L_w_nomoe:
    v_mov_b32 v5, 268435456
    buffer_load_dword v120, v5, s[32:35], 0 offen
    buffer_load_dword v121, v5, s[32:35], 0 offen
    buffer_load_dword v122, v5, s[32:35], 0 offen
    buffer_load_dword v123, v5, s[32:35], 0 offen
    buffer_load_dword v124, v5, s[32:35], 0 offen
    buffer_load_dword v125, v5, s[32:35], 0 offen
    buffer_load_dword v126, v5, s[32:35], 0 offen
    buffer_load_dword v127, v5, s[32:35], 0 offen
    buffer_load_dword v128, v5, s[32:35], 0 offen
    buffer_load_dword v129, v5, s[32:35], 0 offen
    buffer_load_dword v130, v5, s[32:35], 0 offen
    buffer_load_dword v131, v5, s[32:35], 0 offen
    buffer_load_dword v132, v5, s[32:35], 0 offen
    buffer_load_dword v133, v5, s[32:35], 0 offen
    buffer_load_dword v134, v5, s[32:35], 0 offen
    buffer_load_dword v135, v5, s[32:35], 0 offen
    buffer_load_dword v136, v5, s[32:35], 0 offen
    buffer_load_dword v137, v5, s[32:35], 0 offen
    buffer_load_dword v138, v5, s[32:35], 0 offen
    buffer_load_dword v139, v5, s[32:35], 0 offen
    buffer_load_dword v140, v5, s[32:35], 0 offen
    buffer_load_dword v141, v5, s[32:35], 0 offen
    buffer_load_dword v142, v5, s[32:35], 0 offen
    buffer_load_dword v143, v5, s[32:35], 0 offen
L_w_moe:
    s_waitcnt vmcnt(40)
    s_barrier
    s_mov_b32 s67, 200000
    s_waitcnt vmcnt(24)
    s_branch L_gw_test
L_gw_check:
    s_waitcnt vmcnt(0)
L_gw_test:
    v_cmp_ne_u32 vcc, s26, v33
    v_cmp_ne_u32 s[30:31], s26, v35
    s_or_b64 vcc, vcc, s[30:31]
    v_cmp_ne_u32 s[30:31], s26, v37
    s_or_b64 vcc, vcc, s[30:31]
    v_cmp_ne_u32 s[30:31], s26, v39
    s_or_b64 vcc, vcc, s[30:31]
    v_cmp_ne_u32 s[30:31], s26, v41
    s_or_b64 vcc, vcc, s[30:31]
    v_cmp_ne_u32 s[30:31], s26, v43
    s_or_b64 vcc, vcc, s[30:31]
    v_cmp_ne_u32 s[30:31], s26, v45
    s_or_b64 vcc, vcc, s[30:31]
    v_cmp_ne_u32 s[30:31], s26, v47
    s_or_b64 vcc, vcc, s[30:31]
    v_cmp_ne_u32 s[30:31], s26, v49
    s_or_b64 vcc, vcc, s[30:31]
    v_cmp_ne_u32 s[30:31], s26, v51
    s_or_b64 vcc, vcc, s[30:31]
    v_cmp_ne_u32 s[30:31], s26, v53
    s_or_b64 vcc, vcc, s[30:31]
    v_cmp_ne_u32 s[30:31], s26, v55
    s_or_b64 vcc, vcc, s[30:31]
    v_cmp_ne_u32 s[30:31], s26, v57
    s_or_b64 vcc, vcc, s[30:31]
    v_cmp_ne_u32 s[30:31], s26, v59
    s_or_b64 vcc, vcc, s[30:31]
    v_cmp_ne_u32 s[30:31], s26, v61
    s_or_b64 vcc, vcc, s[30:31]
    v_cmp_ne_u32 s[30:31], s26, v63
    s_or_b64 vcc, vcc, s[30:31]
    v_cmp_ne_u32 s[30:31], s26, v65
    s_or_b64 vcc, vcc, s[30:31]
    v_cmp_ne_u32 s[30:31], s26, v67
    s_or_b64 vcc, vcc, s[30:31]
    v_cmp_ne_u32 s[30:31], s26, v69
    s_or_b64 vcc, vcc, s[30:31]
    v_cmp_ne_u32 s[30:31], s26, v71
    s_or_b64 vcc, vcc, s[30:31]
    v_cmp_ne_u32 s[30:31], s26, v73
    s_or_b64 vcc, vcc, s[30:31]
    v_cmp_ne_u32 s[30:31], s26, v75
    s_or_b64 vcc, vcc, s[30:31]
    v_cmp_ne_u32 s[30:31], s26, v77
    s_or_b64 vcc, vcc, s[30:31]
    v_cmp_ne_u32 s[30:31], s26, v79
    s_or_b64 vcc, vcc, s[30:31]
    v_cmp_ne_u32 s[30:31], s26, v81
    s_or_b64 vcc, vcc, s[30:31]
    v_cmp_ne_u32 s[30:31], s26, v83
    s_or_b64 vcc, vcc, s[30:31]
    v_cmp_ne_u32 s[30:31], s26, v85
    s_or_b64 vcc, vcc, s[30:31]
    v_cmp_ne_u32 s[30:31], s26, v87
    s_or_b64 vcc, vcc, s[30:31]
    v_cmp_ne_u32 s[30:31], s26, v89
    s_or_b64 vcc, vcc, s[30:31]
    v_cmp_ne_u32 s[30:31], s26, v91
    s_or_b64 vcc, vcc, s[30:31]
    v_cmp_ne_u32 s[30:31], s26, v93
    s_or_b64 vcc, vcc, s[30:31]
    v_cmp_ne_u32 s[30:31], s26, v95
    s_or_b64 vcc, vcc, s[30:31]
    s_cbranch_vccz L_gw_ok
    s_sleep 4
    s_add_u32 s36, s24, 0xa0c600
    s_addc_u32 s37, s25, 0
    s_mov_b32 s38, 0x40000
    s_mov_b32 s39, 0x00020000
    s_lshl_b32 s58, s28, 14
    v_lshlrev_b32 v22, 4, v255
    s_mov_b32 s59, s58
    buffer_load_dwordx4 v[32:35], v22, s[36:39], s59 offen sc1
    s_add_u32 s59, s59, 1024
    buffer_load_dwordx4 v[36:39], v22, s[36:39], s59 offen sc1
    s_add_u32 s59, s59, 1024
    buffer_load_dwordx4 v[40:43], v22, s[36:39], s59 offen sc1
    s_add_u32 s59, s59, 1024
    buffer_load_dwordx4 v[44:47], v22, s[36:39], s59 offen sc1
    s_add_u32 s59, s59, 1024
    buffer_load_dwordx4 v[48:51], v22, s[36:39], s59 offen sc1
    s_add_u32 s59, s59, 1024
    buffer_load_dwordx4 v[52:55], v22, s[36:39], s59 offen sc1
    s_add_u32 s59, s59, 1024
    buffer_load_dwordx4 v[56:59], v22, s[36:39], s59 offen sc1
    s_add_u32 s59, s59, 1024
    buffer_load_dwordx4 v[60:63], v22, s[36:39], s59 offen sc1
    s_add_u32 s59, s59, 1024
    buffer_load_dwordx4 v[64:67], v22, s[36:39], s59 offen sc1
    s_add_u32 s59, s59, 1024
    buffer_load_dwordx4 v[68:71], v22, s[36:39], s59 offen sc1
    s_add_u32 s59, s59, 1024
    buffer_load_dwordx4 v[72:75], v22, s[36:39], s59 offen sc1
    s_add_u32 s59, s59, 1024
    buffer_load_dwordx4 v[76:79], v22, s[36:39], s59 offen sc1
    s_add_u32 s59, s59, 1024
    buffer_load_dwordx4 v[80:83], v22, s[36:39], s59 offen sc1
    s_add_u32 s59, s59, 1024
    buffer_load_dwordx4 v[84:87], v22, s[36:39], s59 offen sc1
    s_add_u32 s59, s59, 1024
    buffer_load_dwordx4 v[88:91], v22, s[36:39], s59 offen sc1
    s_add_u32 s59, s59, 1024
    buffer_load_dwordx4 v[92:95], v22, s[36:39], s59 offen sc1
    s_sub_u32 s67, s67, 1
    s_cmp_lg_u32 s67, 0
    s_cbranch_scc1 L_gw_check
    s_waitcnt vmcnt(0)
L_gw_ok:
    v_add_f32 v32, v32, v36
    v_add_f32 v34, v34, v38
    v_add_f32 v32, v32, v40
    v_add_f32 v34, v34, v42
    v_add_f32 v32, v32, v44
    v_add_f32 v34, v34, v46
    v_add_f32 v32, v32, v48
    v_add_f32 v34, v34, v50
    v_add_f32 v32, v32, v52
    v_add_f32 v34, v34, v54
    v_add_f32 v32, v32, v56
    v_add_f32 v34, v34, v58
    v_add_f32 v32, v32, v60
    v_add_f32 v34, v34, v62
    v_add_f32 v32, v32, v64
    v_add_f32 v34, v34, v66
    v_add_f32 v32, v32, v68
    v_add_f32 v34, v34, v70
    v_add_f32 v32, v32, v72
    v_add_f32 v34, v34, v74
    v_add_f32 v32, v32, v76
    v_add_f32 v34, v34, v78
    v_add_f32 v32, v32, v80
    v_add_f32 v34, v34, v82
    v_add_f32 v32, v32, v84
    v_add_f32 v34, v34, v86
    v_add_f32 v32, v32, v88
    v_add_f32 v34, v34, v90
    v_add_f32 v32, v32, v92
    v_add_f32 v34, v34, v94
    v_mov_b32 v33, v34
    v_lshlrev_b32 v22, 3, v255
    v_add_u32 v22, 161792, v22
    ds_write_b64 v22, v[32:33]
    s_waitcnt lgkmcnt(0)
    s_barrier
    s_branch L_h_moe
L_h_idle:
    s_cmp_eq_u32 s3, 4
    s_cbranch_scc0 L_h_noearly
    s_mov_b32 s36, s22
    s_mov_b32 s37, s23
    s_mov_b32 s38, 0x100
    s_mov_b32 s39, 0x00020000
    v_mov_b32 v3, 128
    buffer_load_dword v226, v3, s[36:39], 0 offen
    s_add_u32 s36, s24, 0xa04500
    s_addc_u32 s37, s25, 0
    s_mov_b32 s38, 0x100
    s_mov_b32 s39, 0x00020000
    v_mov_b32 v4, 0
    buffer_load_dword v227, v4, s[36:39], 0 offen
L_h_noearly:
    s_barrier
    v_mov_b32 v10, 163328
    ds_read_b32 v11, v10
    s_waitcnt lgkmcnt(0)
    v_readfirstlane_b32 s26, v11
    s_cmp_eq_u32 s3, 4
    s_cbranch_scc0 L_h_idle5
    s_cmp_eq_u32 s2, 4
    s_cbranch_scc1 L_h_sel
    v_lshlrev_b32 v4, 20, v255
    s_mov_b32 s36, s6
    s_mov_b32 s37, s7
    s_mov_b32 s38, 0x258000
    s_mov_b32 s39, 0x00020000
    buffer_load_dword v228, v4, s[36:39], 0 offen
    s_mov_b32 s36, s4
    s_mov_b32 s37, s5
    s_mov_b32 s38, 0x280000
    s_mov_b32 s39, 0x00020000
    buffer_load_dword v229, v4, s[36:39], 0 offen
    s_mov_b32 s36, s24
    s_mov_b32 s37, s25
    s_mov_b32 s38, 0xae2900
    s_mov_b32 s39, 0x00020000
    v_mov_b32 v3, 0
    buffer_load_dword v240, v3, s[36:39], 0 offen
    v_mov_b32 v3, 2621696
    buffer_load_dword v241, v3, s[36:39], 0 offen
    v_mov_b32 v3, 5243392
    buffer_load_dword v242, v3, s[36:39], 0 offen
    v_mov_b32 v3, 7881472
    buffer_load_dword v243, v3, s[36:39], 0 offen
    v_mov_b32 v3, 9978880
    buffer_load_dword v244, v3, s[36:39], 0 offen
    v_mov_b32 v3, 10503424
    buffer_load_dword v245, v3, s[36:39], 0 offen
    v_mov_b32 v3, 11413504
    buffer_load_dword v246, v3, s[36:39], 0 offen
    s_mov_b32 s36, s20
    s_mov_b32 s37, s21
    s_mov_b32 s38, 0x280000
    s_mov_b32 s39, 0x00020000
    buffer_load_dword v230, v4, s[36:39], 0 offen
    s_mov_b32 s36, s8
    s_mov_b32 s37, s9
    s_mov_b32 s38, 0xc8000
    s_mov_b32 s39, 0x00020000
    buffer_load_dword v231, v4, s[36:39], 0 offen
    s_mov_b32 s36, s14
    s_mov_b32 s37, s15
    s_mov_b32 s38, 0x1e0000
    s_mov_b32 s39, 0x00020000
    buffer_load_dword v232, v4, s[36:39], 0 offen
    s_mov_b32 s36, s16
    s_mov_b32 s37, s17
    s_mov_b32 s38, 0x1e0000
    s_mov_b32 s39, 0x00020000
    buffer_load_dword v233, v4, s[36:39], 0 offen
    s_mov_b32 s36, s18
    s_mov_b32 s37, s19
    s_mov_b32 s38, 0x1e0000
    s_mov_b32 s39, 0x00020000
    buffer_load_dword v234, v4, s[36:39], 0 offen
    s_branch L_h_bf
L_h_sel:
    s_add_u32 s40, s24, 0xa58800
    s_addc_u32 s41, s25, 0
    s_mov_b32 s42, 0x8000
    s_mov_b32 s43, 0x00020000
    v_lshlrev_b32 v5, 7, v255
    s_mov_b32 s67, 200000
L_sel_f0:
    s_mov_b32 s29, 0
    buffer_load_dword v10, v5, s[40:43], s29 offen sc1
    s_mov_b32 s29, 8192
    buffer_load_dword v11, v5, s[40:43], s29 offen sc1
    s_mov_b32 s29, 16384
    buffer_load_dword v12, v5, s[40:43], s29 offen sc1
    s_mov_b32 s29, 24576
    buffer_load_dword v13, v5, s[40:43], s29 offen sc1
    s_waitcnt vmcnt(0)
    v_cmp_ne_u32 vcc, s26, v10
    v_cmp_ne_u32 s[30:31], s26, v11
    s_or_b64 vcc, vcc, s[30:31]
    v_cmp_ne_u32 s[30:31], s26, v12
    s_or_b64 vcc, vcc, s[30:31]
    v_cmp_ne_u32 s[30:31], s26, v13
    s_or_b64 vcc, vcc, s[30:31]
    s_cbranch_vccz L_sel_f0_ok
    s_sleep 8
    s_sub_u32 s67, s67, 1
    s_cmp_lg_u32 s67, 0
    s_cbranch_scc1 L_sel_f0
L_sel_f0_ok:
    s_add_u32 s40, s24, 0xa0a600
    s_addc_u32 s41, s25, 0
    s_mov_b32 s42, 0x2000
    s_mov_b32 s43, 0x00020000
    v_lshlrev_b32 v3, 4, v255
    buffer_load_dwordx4 v[64:67], v3, s[40:43], 0 offen offset:0 sc1
    buffer_load_dwordx4 v[68:71], v3, s[40:43], 0 offen offset:1024 sc1
    buffer_load_dwordx4 v[72:75], v3, s[40:43], 0 offen offset:2048 sc1
    buffer_load_dwordx4 v[76:79], v3, s[40:43], 0 offen offset:3072 sc1
    v_add_u32 v3, 4096, v3
    buffer_load_dwordx4 v[80:83], v3, s[40:43], 0 offen offset:0 sc1
    buffer_load_dwordx4 v[84:87], v3, s[40:43], 0 offen offset:1024 sc1
    buffer_load_dwordx4 v[88:91], v3, s[40:43], 0 offen offset:2048 sc1
    buffer_load_dwordx4 v[92:95], v3, s[40:43], 0 offen offset:3072 sc1
    v_mov_b32 v96, 0
    v_mov_b32 v97, 0
    s_waitcnt vmcnt(7)
    v_med3_u32 v97, v96, v97, v64
    v_max_u32 v96, v96, v64
    v_med3_u32 v97, v96, v97, v65
    v_max_u32 v96, v96, v65
    v_med3_u32 v97, v96, v97, v66
    v_max_u32 v96, v96, v66
    v_med3_u32 v97, v96, v97, v67
    v_max_u32 v96, v96, v67
    s_waitcnt vmcnt(6)
    v_med3_u32 v97, v96, v97, v68
    v_max_u32 v96, v96, v68
    v_med3_u32 v97, v96, v97, v69
    v_max_u32 v96, v96, v69
    v_med3_u32 v97, v96, v97, v70
    v_max_u32 v96, v96, v70
    v_med3_u32 v97, v96, v97, v71
    v_max_u32 v96, v96, v71
    s_waitcnt vmcnt(5)
    v_med3_u32 v97, v96, v97, v72
    v_max_u32 v96, v96, v72
    v_med3_u32 v97, v96, v97, v73
    v_max_u32 v96, v96, v73
    v_med3_u32 v97, v96, v97, v74
    v_max_u32 v96, v96, v74
    v_med3_u32 v97, v96, v97, v75
    v_max_u32 v96, v96, v75
    s_waitcnt vmcnt(4)
    v_med3_u32 v97, v96, v97, v76
    v_max_u32 v96, v96, v76
    v_med3_u32 v97, v96, v97, v77
    v_max_u32 v96, v96, v77
    v_med3_u32 v97, v96, v97, v78
    v_max_u32 v96, v96, v78
    v_med3_u32 v97, v96, v97, v79
    v_max_u32 v96, v96, v79
    s_waitcnt vmcnt(3)
    v_med3_u32 v97, v96, v97, v80
    v_max_u32 v96, v96, v80
    v_med3_u32 v97, v96, v97, v81
    v_max_u32 v96, v96, v81
    v_med3_u32 v97, v96, v97, v82
    v_max_u32 v96, v96, v82
    v_med3_u32 v97, v96, v97, v83
    v_max_u32 v96, v96, v83
    s_waitcnt vmcnt(2)
    v_med3_u32 v97, v96, v97, v84
    v_max_u32 v96, v96, v84
    v_med3_u32 v97, v96, v97, v85
    v_max_u32 v96, v96, v85
    v_med3_u32 v97, v96, v97, v86
    v_max_u32 v96, v96, v86
    v_med3_u32 v97, v96, v97, v87
    v_max_u32 v96, v96, v87
    s_waitcnt vmcnt(1)
    v_med3_u32 v97, v96, v97, v88
    v_max_u32 v96, v96, v88
    v_med3_u32 v97, v96, v97, v89
    v_max_u32 v96, v96, v89
    v_med3_u32 v97, v96, v97, v90
    v_max_u32 v96, v96, v90
    v_med3_u32 v97, v96, v97, v91
    v_max_u32 v96, v96, v91
    s_waitcnt vmcnt(0)
    v_med3_u32 v97, v96, v97, v92
    v_max_u32 v96, v96, v92
    v_med3_u32 v97, v96, v97, v93
    v_max_u32 v96, v96, v93
    v_med3_u32 v97, v96, v97, v94
    v_max_u32 v96, v96, v94
    v_med3_u32 v97, v96, v97, v95
    v_max_u32 v96, v96, v95
    v_mov_b32 v98, 0
    v_mov_b32 v99, 0
    s_nop 1
    v_mov_b32_dpp v98, v96 row_shr:1 row_mask:0xf bank_mask:0xf
    v_mov_b32_dpp v99, v97 row_shr:1 row_mask:0xf bank_mask:0xf
    v_min_u32 v100, v96, v98
    v_max_u32 v96, v96, v98
    v_max3_u32 v97, v100, v97, v99
    v_mov_b32 v98, 0
    v_mov_b32 v99, 0
    s_nop 1
    v_mov_b32_dpp v98, v96 row_shr:2 row_mask:0xf bank_mask:0xf
    v_mov_b32_dpp v99, v97 row_shr:2 row_mask:0xf bank_mask:0xf
    v_min_u32 v100, v96, v98
    v_max_u32 v96, v96, v98
    v_max3_u32 v97, v100, v97, v99
    v_mov_b32 v98, 0
    v_mov_b32 v99, 0
    s_nop 1
    v_mov_b32_dpp v98, v96 row_shr:4 row_mask:0xf bank_mask:0xf
    v_mov_b32_dpp v99, v97 row_shr:4 row_mask:0xf bank_mask:0xf
    v_min_u32 v100, v96, v98
    v_max_u32 v96, v96, v98
    v_max3_u32 v97, v100, v97, v99
    v_mov_b32 v98, 0
    v_mov_b32 v99, 0
    s_nop 1
    v_mov_b32_dpp v98, v96 row_shr:8 row_mask:0xf bank_mask:0xf
    v_mov_b32_dpp v99, v97 row_shr:8 row_mask:0xf bank_mask:0xf
    v_min_u32 v100, v96, v98
    v_max_u32 v96, v96, v98
    v_max3_u32 v97, v100, v97, v99
    v_mov_b32 v98, 0
    v_mov_b32 v99, 0
    s_nop 1
    v_mov_b32_dpp v98, v96 row_bcast:15 row_mask:0xa bank_mask:0xf
    v_mov_b32_dpp v99, v97 row_bcast:15 row_mask:0xa bank_mask:0xf
    v_min_u32 v100, v96, v98
    v_max_u32 v96, v96, v98
    v_max3_u32 v97, v100, v97, v99
    v_mov_b32 v98, 0
    v_mov_b32 v99, 0
    s_nop 1
    v_mov_b32_dpp v98, v96 row_bcast:31 row_mask:0xc bank_mask:0xf
    v_mov_b32_dpp v99, v97 row_bcast:31 row_mask:0xc bank_mask:0xf
    v_min_u32 v100, v96, v98
    v_max_u32 v96, v96, v98
    v_max3_u32 v97, v100, v97, v99
    s_nop 0
    v_readlane_b32 s60, v96, 63
    v_readlane_b32 s61, v97, 63
    s_and_b32 s60, s60, 0x7ff
    s_and_b32 s61, s61, 0x7ff
    s_add_u32 s40, s24, 0xa50700
    s_addc_u32 s41, s25, 0
    s_mov_b32 s42, 0x10
    s_mov_b32 s43, 0x00020000
    v_mov_b32 v8, s60
    v_mov_b32 v9, s26
    v_mov_b32 v10, s61
    v_mov_b32 v11, s26
    v_mov_b32 v12, 0
    s_mov_b64 exec, 1
    buffer_store_dwordx4 v[8:11], v12, s[40:43], 0 offen sc1
    s_mov_b64 exec, -1
    s_waitcnt vmcnt(0)
    s_branch L_h_bf
L_h_idle5:
    s_cmp_ge_u32 s2, 240
    s_cbranch_scc1 L_h_moe
    s_mul_i32 s68, s2, 205
    s_lshr_b32 s68, s68, 11
    s_mul_i32 s29, s68, 10
    s_sub_u32 s69, s2, s29
    s_mov_b32 s40, s14
    s_mov_b32 s41, s15
    s_mov_b32 s42, 0x1e0000
    s_mov_b32 s43, 0x00020000
    s_mov_b32 s44, s16
    s_mov_b32 s45, s17
    s_mov_b32 s46, 0x1e0000
    s_mov_b32 s47, 0x00020000
    s_mov_b32 s48, s18
    s_mov_b32 s49, s19
    s_mov_b32 s50, 0x1e0000
    s_mov_b32 s51, 0x00020000
    v_lshrrev_b32 v3, 3, v255
    v_and_b32 v4, 7, v255
    v_mul_u32_u24 v5, 3072, v3
    v_lshl_add_u32 v5, v4, 4, v5
    v_mul_u32_u24 v6, 1280, v3
    v_lshl_add_u32 v6, v4, 4, v6
    s_mul_i32 s62, s69, 196608
    s_lshl_b32 s29, s68, 7
    s_add_u32 s62, s62, s29
    s_mul_i32 s63, s68, 81920
    s_lshl_b32 s29, s69, 7
    s_add_u32 s63, s63, s29
    s_mov_b32 m0, 131072
    s_add_u32 s64, s62, 0
    buffer_load_dwordx4 v5, s[40:43], s64 offen lds
    s_mov_b32 m0, 139264
    s_add_u32 s64, s62, 0
    buffer_load_dwordx4 v5, s[44:47], s64 offen lds
    s_mov_b32 m0, 132096
    s_add_u32 s64, s62, 24576
    buffer_load_dwordx4 v5, s[40:43], s64 offen lds
    s_mov_b32 m0, 140288
    s_add_u32 s64, s62, 24576
    buffer_load_dwordx4 v5, s[44:47], s64 offen lds
    s_mov_b32 m0, 133120
    s_add_u32 s64, s62, 49152
    buffer_load_dwordx4 v5, s[40:43], s64 offen lds
    s_mov_b32 m0, 141312
    s_add_u32 s64, s62, 49152
    buffer_load_dwordx4 v5, s[44:47], s64 offen lds
    s_mov_b32 m0, 134144
    s_add_u32 s64, s62, 73728
    buffer_load_dwordx4 v5, s[40:43], s64 offen lds
    s_mov_b32 m0, 142336
    s_add_u32 s64, s62, 73728
    buffer_load_dwordx4 v5, s[44:47], s64 offen lds
    s_mov_b32 m0, 135168
    s_add_u32 s64, s62, 98304
    buffer_load_dwordx4 v5, s[40:43], s64 offen lds
    s_mov_b32 m0, 143360
    s_add_u32 s64, s62, 98304
    buffer_load_dwordx4 v5, s[44:47], s64 offen lds
    s_mov_b32 m0, 136192
    s_add_u32 s64, s62, 122880
    buffer_load_dwordx4 v5, s[40:43], s64 offen lds
    s_mov_b32 m0, 144384
    s_add_u32 s64, s62, 122880
    buffer_load_dwordx4 v5, s[44:47], s64 offen lds
    s_mov_b32 m0, 137216
    s_add_u32 s64, s62, 147456
    buffer_load_dwordx4 v5, s[40:43], s64 offen lds
    s_mov_b32 m0, 145408
    s_add_u32 s64, s62, 147456
    buffer_load_dwordx4 v5, s[44:47], s64 offen lds
    s_mov_b32 m0, 138240
    s_add_u32 s64, s62, 172032
    buffer_load_dwordx4 v5, s[40:43], s64 offen lds
    s_mov_b32 m0, 146432
    s_add_u32 s64, s62, 172032
    buffer_load_dwordx4 v5, s[44:47], s64 offen lds
    s_mov_b32 m0, 147456
    s_add_u32 s64, s63, 0
    buffer_load_dwordx4 v6, s[48:51], s64 offen lds
    s_mov_b32 m0, 148480
    s_add_u32 s64, s63, 10240
    buffer_load_dwordx4 v6, s[48:51], s64 offen lds
    s_mov_b32 m0, 149504
    s_add_u32 s64, s63, 20480
    buffer_load_dwordx4 v6, s[48:51], s64 offen lds
    s_mov_b32 m0, 150528
    s_add_u32 s64, s63, 30720
    buffer_load_dwordx4 v6, s[48:51], s64 offen lds
    s_mov_b32 m0, 151552
    s_add_u32 s64, s63, 40960
    buffer_load_dwordx4 v6, s[48:51], s64 offen lds
    s_mov_b32 m0, 152576
    s_add_u32 s64, s63, 51200
    buffer_load_dwordx4 v6, s[48:51], s64 offen lds
    s_mov_b32 m0, 153600
    s_add_u32 s64, s63, 61440
    buffer_load_dwordx4 v6, s[48:51], s64 offen lds
    s_mov_b32 m0, 154624
    s_add_u32 s64, s63, 71680
    buffer_load_dwordx4 v6, s[48:51], s64 offen lds
    s_branch L_h_moe
L_h_bf:
    v_mov_b32 v10, 163340
    s_mov_b32 s67, 1600000
L_h_go4:
    ds_read_b32 v11, v10
    s_waitcnt lgkmcnt(0)
    v_readfirstlane_b32 s29, v11
    s_cmp_ge_u32 s29, 4
    s_cbranch_scc1 L_h_go4_ok
    s_sleep 4
    s_sub_u32 s67, s67, 1
    s_cmp_lg_u32 s67, 0
    s_cbranch_scc1 L_h_go4
L_h_go4_ok:
    s_setprio 0
    s_and_b32 s29, s2, 7
    s_lshr_b32 s30, s2, 3
    s_and_b32 s31, s30, 3
    s_lshl_b32 s29, s29, 2
    s_add_u32 s56, s29, s31
    s_lshr_b32 s57, s30, 2
    v_add_u32 v3, 0, v255
    v_mul_u32_u24 v4, 6554, v3
    v_lshrrev_b32 v4, 16, v4
    v_mul_u32_u24 v5, 10, v4
    v_sub_u32 v5, v3, v5
    v_mul_u32_u24 v4, 1280, v4
    v_lshl_add_u32 v20, v5, 4, v4
    v_add_u32 v3, 64, v255
    v_mul_u32_u24 v4, 6554, v3
    v_lshrrev_b32 v4, 16, v4
    v_mul_u32_u24 v5, 10, v4
    v_sub_u32 v5, v3, v5
    v_mul_u32_u24 v4, 1280, v4
    v_lshl_add_u32 v21, v5, 4, v4
    v_add_u32 v3, 128, v255
    v_mul_u32_u24 v4, 6554, v3
    v_lshrrev_b32 v4, 16, v4
    v_mul_u32_u24 v5, 10, v4
    v_sub_u32 v5, v3, v5
    v_mul_u32_u24 v4, 1280, v4
    v_lshl_add_u32 v22, v5, 4, v4
    v_add_u32 v3, 192, v255
    v_mul_u32_u24 v4, 6554, v3
    v_lshrrev_b32 v4, 16, v4
    v_mul_u32_u24 v5, 10, v4
    v_sub_u32 v5, v3, v5
    v_mul_u32_u24 v4, 1280, v4
    v_lshl_add_u32 v23, v5, 4, v4
    v_add_u32 v3, 256, v255
    v_mul_u32_u24 v4, 6554, v3
    v_lshrrev_b32 v4, 16, v4
    v_mul_u32_u24 v5, 10, v4
    v_sub_u32 v5, v3, v5
    v_mul_u32_u24 v4, 1280, v4
    v_lshl_add_u32 v24, v5, 4, v4
    s_mov_b32 s32, s8
    s_mov_b32 s33, s9
    s_mov_b32 s34, 0xc8000
    s_mov_b32 s35, 0x00020000
    s_mul_i32 s58, s57, 160
    s_mov_b32 m0, 0
    s_add_u32 s59, s58, 0
    buffer_load_dwordx4 v20, s[32:35], s59 offen lds
    s_mov_b32 m0, 1024
    s_add_u32 s59, s58, 0
    buffer_load_dwordx4 v21, s[32:35], s59 offen lds
    s_mov_b32 m0, 2048
    s_add_u32 s59, s58, 0
    buffer_load_dwordx4 v22, s[32:35], s59 offen lds
    s_mov_b32 m0, 3072
    s_add_u32 s59, s58, 0
    buffer_load_dwordx4 v23, s[32:35], s59 offen lds
    s_mov_b32 m0, 4096
    s_add_u32 s59, s58, 0
    buffer_load_dwordx4 v24, s[32:35], s59 offen lds
    s_waitcnt vmcnt(10)
    s_mov_b32 m0, 5120
    s_add_u32 s59, s58, 40960
    buffer_load_dwordx4 v20, s[32:35], s59 offen lds
    s_mov_b32 m0, 6144
    s_add_u32 s59, s58, 40960
    buffer_load_dwordx4 v21, s[32:35], s59 offen lds
    s_mov_b32 m0, 7168
    s_add_u32 s59, s58, 40960
    buffer_load_dwordx4 v22, s[32:35], s59 offen lds
    s_mov_b32 m0, 8192
    s_add_u32 s59, s58, 40960
    buffer_load_dwordx4 v23, s[32:35], s59 offen lds
    s_mov_b32 m0, 9216
    s_add_u32 s59, s58, 40960
    buffer_load_dwordx4 v24, s[32:35], s59 offen lds
    s_waitcnt vmcnt(10)
    s_mov_b32 m0, 10240
    s_add_u32 s59, s58, 81920
    buffer_load_dwordx4 v20, s[32:35], s59 offen lds
    s_mov_b32 m0, 11264
    s_add_u32 s59, s58, 81920
    buffer_load_dwordx4 v21, s[32:35], s59 offen lds
    s_mov_b32 m0, 12288
    s_add_u32 s59, s58, 81920
    buffer_load_dwordx4 v22, s[32:35], s59 offen lds
    s_mov_b32 m0, 13312
    s_add_u32 s59, s58, 81920
    buffer_load_dwordx4 v23, s[32:35], s59 offen lds
    s_mov_b32 m0, 14336
    s_add_u32 s59, s58, 81920
    buffer_load_dwordx4 v24, s[32:35], s59 offen lds
    s_waitcnt vmcnt(10)
    s_mov_b32 m0, 15360
    s_add_u32 s59, s58, 122880
    buffer_load_dwordx4 v20, s[32:35], s59 offen lds
    s_mov_b32 m0, 16384
    s_add_u32 s59, s58, 122880
    buffer_load_dwordx4 v21, s[32:35], s59 offen lds
    s_mov_b32 m0, 17408
    s_add_u32 s59, s58, 122880
    buffer_load_dwordx4 v22, s[32:35], s59 offen lds
    s_mov_b32 m0, 18432
    s_add_u32 s59, s58, 122880
    buffer_load_dwordx4 v23, s[32:35], s59 offen lds
    s_mov_b32 m0, 19456
    s_add_u32 s59, s58, 122880
    buffer_load_dwordx4 v24, s[32:35], s59 offen lds
    s_waitcnt vmcnt(10)
    s_mov_b32 m0, 20480
    s_add_u32 s59, s58, 163840
    buffer_load_dwordx4 v20, s[32:35], s59 offen lds
    s_mov_b32 m0, 21504
    s_add_u32 s59, s58, 163840
    buffer_load_dwordx4 v21, s[32:35], s59 offen lds
    s_mov_b32 m0, 22528
    s_add_u32 s59, s58, 163840
    buffer_load_dwordx4 v22, s[32:35], s59 offen lds
    s_mov_b32 m0, 23552
    s_add_u32 s59, s58, 163840
    buffer_load_dwordx4 v23, s[32:35], s59 offen lds
    s_mov_b32 m0, 24576
    s_add_u32 s59, s58, 163840
    buffer_load_dwordx4 v24, s[32:35], s59 offen lds
    s_waitcnt vmcnt(10)
    s_mov_b32 m0, 25600
    s_add_u32 s59, s58, 204800
    buffer_load_dwordx4 v20, s[32:35], s59 offen lds
    s_mov_b32 m0, 26624
    s_add_u32 s59, s58, 204800
    buffer_load_dwordx4 v21, s[32:35], s59 offen lds
    s_mov_b32 m0, 27648
    s_add_u32 s59, s58, 204800
    buffer_load_dwordx4 v22, s[32:35], s59 offen lds
    s_mov_b32 m0, 28672
    s_add_u32 s59, s58, 204800
    buffer_load_dwordx4 v23, s[32:35], s59 offen lds
    s_mov_b32 m0, 29696
    s_add_u32 s59, s58, 204800
    buffer_load_dwordx4 v24, s[32:35], s59 offen lds
    s_waitcnt vmcnt(10)
    s_mov_b32 m0, 30720
    s_add_u32 s59, s58, 245760
    buffer_load_dwordx4 v20, s[32:35], s59 offen lds
    s_mov_b32 m0, 31744
    s_add_u32 s59, s58, 245760
    buffer_load_dwordx4 v21, s[32:35], s59 offen lds
    s_mov_b32 m0, 32768
    s_add_u32 s59, s58, 245760
    buffer_load_dwordx4 v22, s[32:35], s59 offen lds
    s_mov_b32 m0, 33792
    s_add_u32 s59, s58, 245760
    buffer_load_dwordx4 v23, s[32:35], s59 offen lds
    s_mov_b32 m0, 34816
    s_add_u32 s59, s58, 245760
    buffer_load_dwordx4 v24, s[32:35], s59 offen lds
    s_waitcnt vmcnt(10)
    s_mov_b32 m0, 35840
    s_add_u32 s59, s58, 286720
    buffer_load_dwordx4 v20, s[32:35], s59 offen lds
    s_mov_b32 m0, 36864
    s_add_u32 s59, s58, 286720
    buffer_load_dwordx4 v21, s[32:35], s59 offen lds
    s_mov_b32 m0, 37888
    s_add_u32 s59, s58, 286720
    buffer_load_dwordx4 v22, s[32:35], s59 offen lds
    s_mov_b32 m0, 38912
    s_add_u32 s59, s58, 286720
    buffer_load_dwordx4 v23, s[32:35], s59 offen lds
    s_mov_b32 m0, 39936
    s_add_u32 s59, s58, 286720
    buffer_load_dwordx4 v24, s[32:35], s59 offen lds
    s_waitcnt vmcnt(10)
    s_mov_b32 m0, 40960
    s_add_u32 s59, s58, 327680
    buffer_load_dwordx4 v20, s[32:35], s59 offen lds
    s_mov_b32 m0, 41984
    s_add_u32 s59, s58, 327680
    buffer_load_dwordx4 v21, s[32:35], s59 offen lds
    s_mov_b32 m0, 43008
    s_add_u32 s59, s58, 327680
    buffer_load_dwordx4 v22, s[32:35], s59 offen lds
    s_mov_b32 m0, 44032
    s_add_u32 s59, s58, 327680
    buffer_load_dwordx4 v23, s[32:35], s59 offen lds
    s_mov_b32 m0, 45056
    s_add_u32 s59, s58, 327680
    buffer_load_dwordx4 v24, s[32:35], s59 offen lds
    s_waitcnt vmcnt(10)
    s_mov_b32 m0, 46080
    s_add_u32 s59, s58, 368640
    buffer_load_dwordx4 v20, s[32:35], s59 offen lds
    s_mov_b32 m0, 47104
    s_add_u32 s59, s58, 368640
    buffer_load_dwordx4 v21, s[32:35], s59 offen lds
    s_mov_b32 m0, 48128
    s_add_u32 s59, s58, 368640
    buffer_load_dwordx4 v22, s[32:35], s59 offen lds
    s_mov_b32 m0, 49152
    s_add_u32 s59, s58, 368640
    buffer_load_dwordx4 v23, s[32:35], s59 offen lds
    s_mov_b32 m0, 50176
    s_add_u32 s59, s58, 368640
    buffer_load_dwordx4 v24, s[32:35], s59 offen lds
    s_waitcnt vmcnt(10)
    s_mov_b32 m0, 51200
    s_add_u32 s59, s58, 409600
    buffer_load_dwordx4 v20, s[32:35], s59 offen lds
    s_mov_b32 m0, 52224
    s_add_u32 s59, s58, 409600
    buffer_load_dwordx4 v21, s[32:35], s59 offen lds
    s_mov_b32 m0, 53248
    s_add_u32 s59, s58, 409600
    buffer_load_dwordx4 v22, s[32:35], s59 offen lds
    s_mov_b32 m0, 54272
    s_add_u32 s59, s58, 409600
    buffer_load_dwordx4 v23, s[32:35], s59 offen lds
    s_mov_b32 m0, 55296
    s_add_u32 s59, s58, 409600
    buffer_load_dwordx4 v24, s[32:35], s59 offen lds
    s_waitcnt vmcnt(10)
    s_mov_b32 m0, 56320
    s_add_u32 s59, s58, 450560
    buffer_load_dwordx4 v20, s[32:35], s59 offen lds
    s_mov_b32 m0, 57344
    s_add_u32 s59, s58, 450560
    buffer_load_dwordx4 v21, s[32:35], s59 offen lds
    s_mov_b32 m0, 58368
    s_add_u32 s59, s58, 450560
    buffer_load_dwordx4 v22, s[32:35], s59 offen lds
    s_mov_b32 m0, 59392
    s_add_u32 s59, s58, 450560
    buffer_load_dwordx4 v23, s[32:35], s59 offen lds
    s_mov_b32 m0, 60416
    s_add_u32 s59, s58, 450560
    buffer_load_dwordx4 v24, s[32:35], s59 offen lds
    s_waitcnt vmcnt(10)
    s_mov_b32 m0, 61440
    s_add_u32 s59, s58, 491520
    buffer_load_dwordx4 v20, s[32:35], s59 offen lds
    s_mov_b32 m0, 62464
    s_add_u32 s59, s58, 491520
    buffer_load_dwordx4 v21, s[32:35], s59 offen lds
    s_mov_b32 m0, 63488
    s_add_u32 s59, s58, 491520
    buffer_load_dwordx4 v22, s[32:35], s59 offen lds
    s_mov_b32 m0, 64512
    s_add_u32 s59, s58, 491520
    buffer_load_dwordx4 v23, s[32:35], s59 offen lds
    s_mov_b32 m0, 65536
    s_add_u32 s59, s58, 491520
    buffer_load_dwordx4 v24, s[32:35], s59 offen lds
    s_waitcnt vmcnt(10)
    s_mov_b32 m0, 66560
    s_add_u32 s59, s58, 532480
    buffer_load_dwordx4 v20, s[32:35], s59 offen lds
    s_mov_b32 m0, 67584
    s_add_u32 s59, s58, 532480
    buffer_load_dwordx4 v21, s[32:35], s59 offen lds
    s_mov_b32 m0, 68608
    s_add_u32 s59, s58, 532480
    buffer_load_dwordx4 v22, s[32:35], s59 offen lds
    s_mov_b32 m0, 69632
    s_add_u32 s59, s58, 532480
    buffer_load_dwordx4 v23, s[32:35], s59 offen lds
    s_mov_b32 m0, 70656
    s_add_u32 s59, s58, 532480
    buffer_load_dwordx4 v24, s[32:35], s59 offen lds
    s_waitcnt vmcnt(10)
    s_mov_b32 m0, 71680
    s_add_u32 s59, s58, 573440
    buffer_load_dwordx4 v20, s[32:35], s59 offen lds
    s_mov_b32 m0, 72704
    s_add_u32 s59, s58, 573440
    buffer_load_dwordx4 v21, s[32:35], s59 offen lds
    s_mov_b32 m0, 73728
    s_add_u32 s59, s58, 573440
    buffer_load_dwordx4 v22, s[32:35], s59 offen lds
    s_mov_b32 m0, 74752
    s_add_u32 s59, s58, 573440
    buffer_load_dwordx4 v23, s[32:35], s59 offen lds
    s_mov_b32 m0, 75776
    s_add_u32 s59, s58, 573440
    buffer_load_dwordx4 v24, s[32:35], s59 offen lds
    s_waitcnt vmcnt(10)
    s_mov_b32 m0, 76800
    s_add_u32 s59, s58, 614400
    buffer_load_dwordx4 v20, s[32:35], s59 offen lds
    s_mov_b32 m0, 77824
    s_add_u32 s59, s58, 614400
    buffer_load_dwordx4 v21, s[32:35], s59 offen lds
    s_mov_b32 m0, 78848
    s_add_u32 s59, s58, 614400
    buffer_load_dwordx4 v22, s[32:35], s59 offen lds
    s_mov_b32 m0, 79872
    s_add_u32 s59, s58, 614400
    buffer_load_dwordx4 v23, s[32:35], s59 offen lds
    s_mov_b32 m0, 80896
    s_add_u32 s59, s58, 614400
    buffer_load_dwordx4 v24, s[32:35], s59 offen lds
    s_waitcnt vmcnt(10)
    s_mov_b32 m0, 81920
    s_add_u32 s59, s58, 655360
    buffer_load_dwordx4 v20, s[32:35], s59 offen lds
    s_mov_b32 m0, 82944
    s_add_u32 s59, s58, 655360
    buffer_load_dwordx4 v21, s[32:35], s59 offen lds
    s_mov_b32 m0, 83968
    s_add_u32 s59, s58, 655360
    buffer_load_dwordx4 v22, s[32:35], s59 offen lds
    s_mov_b32 m0, 84992
    s_add_u32 s59, s58, 655360
    buffer_load_dwordx4 v23, s[32:35], s59 offen lds
    s_mov_b32 m0, 86016
    s_add_u32 s59, s58, 655360
    buffer_load_dwordx4 v24, s[32:35], s59 offen lds
    s_waitcnt vmcnt(10)
    s_mov_b32 m0, 87040
    s_add_u32 s59, s58, 696320
    buffer_load_dwordx4 v20, s[32:35], s59 offen lds
    s_mov_b32 m0, 88064
    s_add_u32 s59, s58, 696320
    buffer_load_dwordx4 v21, s[32:35], s59 offen lds
    s_mov_b32 m0, 89088
    s_add_u32 s59, s58, 696320
    buffer_load_dwordx4 v22, s[32:35], s59 offen lds
    s_mov_b32 m0, 90112
    s_add_u32 s59, s58, 696320
    buffer_load_dwordx4 v23, s[32:35], s59 offen lds
    s_mov_b32 m0, 91136
    s_add_u32 s59, s58, 696320
    buffer_load_dwordx4 v24, s[32:35], s59 offen lds
    s_waitcnt vmcnt(10)
    s_mov_b32 m0, 92160
    s_add_u32 s59, s58, 737280
    buffer_load_dwordx4 v20, s[32:35], s59 offen lds
    s_mov_b32 m0, 93184
    s_add_u32 s59, s58, 737280
    buffer_load_dwordx4 v21, s[32:35], s59 offen lds
    s_mov_b32 m0, 94208
    s_add_u32 s59, s58, 737280
    buffer_load_dwordx4 v22, s[32:35], s59 offen lds
    s_mov_b32 m0, 95232
    s_add_u32 s59, s58, 737280
    buffer_load_dwordx4 v23, s[32:35], s59 offen lds
    s_mov_b32 m0, 96256
    s_add_u32 s59, s58, 737280
    buffer_load_dwordx4 v24, s[32:35], s59 offen lds
    s_waitcnt vmcnt(10)
    s_mov_b32 m0, 97280
    s_add_u32 s59, s58, 778240
    buffer_load_dwordx4 v20, s[32:35], s59 offen lds
    s_mov_b32 m0, 98304
    s_add_u32 s59, s58, 778240
    buffer_load_dwordx4 v21, s[32:35], s59 offen lds
    s_mov_b32 m0, 99328
    s_add_u32 s59, s58, 778240
    buffer_load_dwordx4 v22, s[32:35], s59 offen lds
    s_mov_b32 m0, 100352
    s_add_u32 s59, s58, 778240
    buffer_load_dwordx4 v23, s[32:35], s59 offen lds
    s_mov_b32 m0, 101376
    s_add_u32 s59, s58, 778240
    buffer_load_dwordx4 v24, s[32:35], s59 offen lds
    s_waitcnt vmcnt(10)
    s_waitcnt vmcnt(0)
    s_endpgm
L_h_moe:
    s_setprio 3
    s_cmp_ge_u32 s2, 250
    s_cbranch_scc1 L_end
    s_cmp_ge_u32 s2, 240
    s_cbranch_scc1 L_h_fin
    s_mul_i32 s68, s2, 205
    s_lshr_b32 s68, s68, 11
    s_mul_i32 s29, s68, 10
    s_sub_u32 s69, s2, s29
    s_add_u32 s40, s24, 0xa50700
    s_addc_u32 s41, s25, 0
    s_mov_b32 s42, 0x10
    s_mov_b32 s43, 0x00020000
    s_mov_b32 s67, 200000
    v_mov_b32 v5, 0
L_g_idx:
    buffer_load_dwordx4 v[8:11], v5, s[40:43], 0 offen sc1
    s_waitcnt vmcnt(0)
    v_readfirstlane_b32 s60, v8
    v_readfirstlane_b32 s29, v9
    v_readfirstlane_b32 s61, v10
    v_readfirstlane_b32 s30, v11
    s_xor_b32 s29, s29, s26
    s_xor_b32 s30, s30, s26
    s_or_b32 s29, s29, s30
    s_cmp_eq_u32 s29, 0
    s_cbranch_scc1 L_g_idx_ok
    s_sleep 8
    s_sub_u32 s67, s67, 1
    s_cmp_lg_u32 s67, 0
    s_cbranch_scc1 L_g_idx
L_g_idx_ok:
    s_mov_b32 s32, s4
    s_mov_b32 s33, s5
    s_mov_b32 s34, 0x280000
    s_mov_b32 s35, 0x00020000
    s_add_u32 s36, s24, 0xa04600
    s_addc_u32 s37, s25, 0
    s_mov_b32 s38, 0x4000
    s_mov_b32 s39, 0x00020000
    v_and_b32 v5, 15, v255
    v_lshrrev_b32 v6, 4, v255
    v_mov_b32 v7, 131072
    v_mov_b32 v8, s60
    v_mov_b32 v9, s61
    v_cmp_eq_u32 vcc, 0, v5
    v_cmp_eq_u32 s[30:31], 1, v5
    s_nop 0
    v_cndmask_b32 v7, v7, v8, vcc
    v_cndmask_b32 v7, v7, v9, s[30:31]
    v_mul_u32_u24 v8, 1280, v7
    v_lshl_add_u32 v8, v6, 4, v8
    v_lshlrev_b32 v9, 3, v7
    s_lshl_b32 s29, s69, 7
    buffer_load_dwordx4 v[16:19], v8, s[32:35], s29 offen
    buffer_load_dwordx4 v[20:23], v8, s[32:35], s29 offen offset:64
    buffer_load_dwordx2 v[12:13], v9, s[36:39], 0 offen sc1
    v_bfe_u32 v8, v255, 2, 2
    v_and_b32 v9, 3, v255
    v_lshl_add_u32 v8, v6, 3, v8
    v_lshlrev_b32 v8, 7, v8
    v_lshl_add_u32 v8, v9, 3, v8
    v_add_u32 v24, 131072, v8
    v_add_u32 v25, 147456, v8
    v_mov_b32 v32, 0
    v_mov_b32 v33, 0
    v_mov_b32 v34, 0
    v_mov_b32 v35, 0
    v_mov_b32 v36, 0
    v_mov_b32 v37, 0
    v_mov_b32 v38, 0
    v_mov_b32 v39, 0
    v_mov_b32 v40, 0
    v_mov_b32 v41, 0
    v_mov_b32 v42, 0
    v_mov_b32 v43, 0
    v_mov_b32 v44, 0
    v_mov_b32 v45, 0
    v_mov_b32 v46, 0
    v_mov_b32 v47, 0
    v_mov_b32 v48, 0
    v_mov_b32 v49, 0
    v_mov_b32 v50, 0
    v_mov_b32 v51, 0
    v_mov_b32 v52, 0
    v_mov_b32 v53, 0
    v_mov_b32 v54, 0
    v_mov_b32 v55, 0
    v_mov_b32 v56, 0
    v_mov_b32 v57, 0
    v_mov_b32 v58, 0
    v_mov_b32 v59, 0
    v_mov_b32 v60, 0
    v_mov_b32 v61, 0
    v_mov_b32 v62, 0
    v_mov_b32 v63, 0
    s_waitcnt vmcnt(0)
    v_mul_f32 v12, v12, v13
    v_sub_f32 v12, 0, v12
    v_lshlrev_b32 v14, 16, v16
    v_and_b32 v15, 0xffff0000, v16
    v_fma_f32 v14, v14, v13, v12
    v_fma_f32 v15, v15, v13, v12
    v_cvt_pk_bf16_f32 v16, v14, v15
    v_lshlrev_b32 v14, 16, v17
    v_and_b32 v15, 0xffff0000, v17
    v_fma_f32 v14, v14, v13, v12
    v_fma_f32 v15, v15, v13, v12
    v_cvt_pk_bf16_f32 v17, v14, v15
    v_lshlrev_b32 v14, 16, v18
    v_and_b32 v15, 0xffff0000, v18
    v_fma_f32 v14, v14, v13, v12
    v_fma_f32 v15, v15, v13, v12
    v_cvt_pk_bf16_f32 v18, v14, v15
    v_lshlrev_b32 v14, 16, v19
    v_and_b32 v15, 0xffff0000, v19
    v_fma_f32 v14, v14, v13, v12
    v_fma_f32 v15, v15, v13, v12
    v_cvt_pk_bf16_f32 v19, v14, v15
    v_lshlrev_b32 v14, 16, v20
    v_and_b32 v15, 0xffff0000, v20
    v_fma_f32 v14, v14, v13, v12
    v_fma_f32 v15, v15, v13, v12
    v_cvt_pk_bf16_f32 v20, v14, v15
    v_lshlrev_b32 v14, 16, v21
    v_and_b32 v15, 0xffff0000, v21
    v_fma_f32 v14, v14, v13, v12
    v_fma_f32 v15, v15, v13, v12
    v_cvt_pk_bf16_f32 v21, v14, v15
    v_lshlrev_b32 v14, 16, v22
    v_and_b32 v15, 0xffff0000, v22
    v_fma_f32 v14, v14, v13, v12
    v_fma_f32 v15, v15, v13, v12
    v_cvt_pk_bf16_f32 v22, v14, v15
    v_lshlrev_b32 v14, 16, v23
    v_and_b32 v15, 0xffff0000, v23
    v_fma_f32 v14, v14, v13, v12
    v_fma_f32 v15, v15, v13, v12
    v_cvt_pk_bf16_f32 v23, v14, v15
    ds_read_b64_tr_b16 v[64:65], v24 offset:0
    ds_read_b64_tr_b16 v[66:67], v24 offset:512
    ds_read_b64_tr_b16 v[68:69], v24 offset:32
    ds_read_b64_tr_b16 v[70:71], v24 offset:544
    ds_read_b64_tr_b16 v[72:73], v24 offset:64
    ds_read_b64_tr_b16 v[74:75], v24 offset:576
    ds_read_b64_tr_b16 v[76:77], v24 offset:96
    ds_read_b64_tr_b16 v[78:79], v24 offset:608
    ds_read_b64_tr_b16 v[80:81], v24 offset:8192
    ds_read_b64_tr_b16 v[82:83], v24 offset:8704
    ds_read_b64_tr_b16 v[84:85], v24 offset:8224
    ds_read_b64_tr_b16 v[86:87], v24 offset:8736
    ds_read_b64_tr_b16 v[88:89], v24 offset:8256
    ds_read_b64_tr_b16 v[90:91], v24 offset:8768
    ds_read_b64_tr_b16 v[92:93], v24 offset:8288
    ds_read_b64_tr_b16 v[94:95], v24 offset:8800
    s_waitcnt lgkmcnt(0)
    v_mfma_f32_16x16x32_bf16 v[32:35], v[16:19], v[64:67], v[32:35]
    v_mfma_f32_16x16x32_bf16 v[36:39], v[16:19], v[68:71], v[36:39]
    v_mfma_f32_16x16x32_bf16 v[40:43], v[16:19], v[72:75], v[40:43]
    v_mfma_f32_16x16x32_bf16 v[44:47], v[16:19], v[76:79], v[44:47]
    v_mfma_f32_16x16x32_bf16 v[48:51], v[16:19], v[80:83], v[48:51]
    v_mfma_f32_16x16x32_bf16 v[52:55], v[16:19], v[84:87], v[52:55]
    v_mfma_f32_16x16x32_bf16 v[56:59], v[16:19], v[88:91], v[56:59]
    v_mfma_f32_16x16x32_bf16 v[60:63], v[16:19], v[92:95], v[60:63]
    ds_read_b64_tr_b16 v[64:65], v24 offset:4096
    ds_read_b64_tr_b16 v[66:67], v24 offset:4608
    ds_read_b64_tr_b16 v[68:69], v24 offset:4128
    ds_read_b64_tr_b16 v[70:71], v24 offset:4640
    ds_read_b64_tr_b16 v[72:73], v24 offset:4160
    ds_read_b64_tr_b16 v[74:75], v24 offset:4672
    ds_read_b64_tr_b16 v[76:77], v24 offset:4192
    ds_read_b64_tr_b16 v[78:79], v24 offset:4704
    ds_read_b64_tr_b16 v[80:81], v24 offset:12288
    ds_read_b64_tr_b16 v[82:83], v24 offset:12800
    ds_read_b64_tr_b16 v[84:85], v24 offset:12320
    ds_read_b64_tr_b16 v[86:87], v24 offset:12832
    ds_read_b64_tr_b16 v[88:89], v24 offset:12352
    ds_read_b64_tr_b16 v[90:91], v24 offset:12864
    ds_read_b64_tr_b16 v[92:93], v24 offset:12384
    ds_read_b64_tr_b16 v[94:95], v24 offset:12896
    s_waitcnt lgkmcnt(0)
    v_mfma_f32_16x16x32_bf16 v[32:35], v[20:23], v[64:67], v[32:35]
    v_mfma_f32_16x16x32_bf16 v[36:39], v[20:23], v[68:71], v[36:39]
    v_mfma_f32_16x16x32_bf16 v[40:43], v[20:23], v[72:75], v[40:43]
    v_mfma_f32_16x16x32_bf16 v[44:47], v[20:23], v[76:79], v[44:47]
    v_mfma_f32_16x16x32_bf16 v[48:51], v[20:23], v[80:83], v[48:51]
    v_mfma_f32_16x16x32_bf16 v[52:55], v[20:23], v[84:87], v[52:55]
    v_mfma_f32_16x16x32_bf16 v[56:59], v[20:23], v[88:91], v[56:59]
    v_mfma_f32_16x16x32_bf16 v[60:63], v[20:23], v[92:95], v[60:63]
    v_lshlrev_b32 v8, 2, v255
    v_add_u32 v8, 155648, v8
    s_nop 7
    s_mov_b64 exec, 0xffff
    ds_write_b32 v8, v32 offset:0
    ds_write_b32 v8, v33 offset:256
    ds_write_b32 v8, v36 offset:64
    ds_write_b32 v8, v37 offset:320
    ds_write_b32 v8, v40 offset:128
    ds_write_b32 v8, v41 offset:384
    ds_write_b32 v8, v44 offset:192
    ds_write_b32 v8, v45 offset:448
    ds_write_b32 v8, v48 offset:512
    ds_write_b32 v8, v49 offset:768
    ds_write_b32 v8, v52 offset:576
    ds_write_b32 v8, v53 offset:832
    ds_write_b32 v8, v56 offset:640
    ds_write_b32 v8, v57 offset:896
    ds_write_b32 v8, v60 offset:704
    ds_write_b32 v8, v61 offset:960
    s_add_u32 s32, s24, 0xa88800
    s_addc_u32 s33, s25, 0
    s_mov_b32 s34, 0x3c000
    s_mov_b32 s35, 0x00020000
    s_mov_b64 exec, -1
    v_lshlrev_b32 v9, 4, v255
    v_add_u32 v8, 155648, v9
    s_waitcnt lgkmcnt(0)
    ds_read_b128 v[12:15], v8
    s_lshl_b32 s29, s2, 10
    s_waitcnt lgkmcnt(0)
    buffer_store_dwordx4 v[12:15], v9, s[32:35], s29 offen sc1
    s_waitcnt vmcnt(0)
    s_add_u32 s52, s24, 0xa70800
    s_addc_u32 s53, s25, 0
    s_mov_b32 s54, 0x8000
    s_mov_b32 s55, 0x00020000
    s_lshl_b32 s29, s2, 7
    v_mov_b32 v10, s29
    v_mov_b32 v11, s26
    s_mov_b64 s[30:31], exec
    s_mov_b64 exec, 1
    buffer_store_dword v11, v10, s[52:55], 0 offen sc1
    s_mov_b64 exec, s[30:31]
    v_mov_b32 v10, 163340
    s_mov_b32 s67, 1600000
L_d_go:
    ds_read_b32 v11, v10
    s_waitcnt lgkmcnt(0)
    v_readfirstlane_b32 s29, v11
    s_cmp_ge_u32 s29, 4
    s_cbranch_scc1 L_d_go_ok
    s_sleep 4
    s_sub_u32 s67, s67, 1
    s_cmp_lg_u32 s67, 0
    s_cbranch_scc1 L_d_go
L_d_go_ok:
    s_setprio 0
    s_add_u32 s40, s24, 0xa70800
    s_addc_u32 s41, s25, 0
    s_mov_b32 s42, 0x8000
    s_mov_b32 s43, 0x00020000
    s_mul_i32 s29, s68, 10
    v_min_u32 v5, 9, v255
    v_add_u32 v5, s29, v5
    v_lshlrev_b32 v5, 7, v5
    s_mov_b32 s67, 200000
L_d_fg:
    buffer_load_dword v10, v5, s[40:43], 0 offen sc1
    s_waitcnt vmcnt(0)
    v_cmp_ne_u32 vcc, s26, v10
    s_cbranch_vccz L_d_fg_ok
    s_sleep 8
    s_sub_u32 s67, s67, 1
    s_cmp_lg_u32 s67, 0
    s_cbranch_scc1 L_d_fg
L_d_fg_ok:
    s_mul_i32 s56, s68, 10240
    v_lshlrev_b32 v9, 4, v255
    buffer_load_dwordx4 v[32:35], v9, s[32:35], s56 offen sc1
    s_add_u32 s56, s56, 1024
    buffer_load_dwordx4 v[36:39], v9, s[32:35], s56 offen sc1
    s_add_u32 s56, s56, 1024
    buffer_load_dwordx4 v[40:43], v9, s[32:35], s56 offen sc1
    s_add_u32 s56, s56, 1024
    buffer_load_dwordx4 v[44:47], v9, s[32:35], s56 offen sc1
    s_add_u32 s56, s56, 1024
    buffer_load_dwordx4 v[48:51], v9, s[32:35], s56 offen sc1
    s_add_u32 s56, s56, 1024
    buffer_load_dwordx4 v[52:55], v9, s[32:35], s56 offen sc1
    s_add_u32 s56, s56, 1024
    buffer_load_dwordx4 v[56:59], v9, s[32:35], s56 offen sc1
    s_add_u32 s56, s56, 1024
    buffer_load_dwordx4 v[60:63], v9, s[32:35], s56 offen sc1
    s_add_u32 s56, s56, 1024
    buffer_load_dwordx4 v[64:67], v9, s[32:35], s56 offen sc1
    s_add_u32 s56, s56, 1024
    buffer_load_dwordx4 v[68:71], v9, s[32:35], s56 offen sc1
    s_waitcnt vmcnt(8)
    v_add_f32 v32, v32, v36
    v_add_f32 v33, v33, v37
    v_add_f32 v34, v34, v38
    v_add_f32 v35, v35, v39
    s_waitcnt vmcnt(7)
    v_add_f32 v32, v32, v40
    v_add_f32 v33, v33, v41
    v_add_f32 v34, v34, v42
    v_add_f32 v35, v35, v43
    s_waitcnt vmcnt(6)
    v_add_f32 v32, v32, v44
    v_add_f32 v33, v33, v45
    v_add_f32 v34, v34, v46
    v_add_f32 v35, v35, v47
    s_waitcnt vmcnt(5)
    v_add_f32 v32, v32, v48
    v_add_f32 v33, v33, v49
    v_add_f32 v34, v34, v50
    v_add_f32 v35, v35, v51
    s_waitcnt vmcnt(4)
    v_add_f32 v32, v32, v52
    v_add_f32 v33, v33, v53
    v_add_f32 v34, v34, v54
    v_add_f32 v35, v35, v55
    s_waitcnt vmcnt(3)
    v_add_f32 v32, v32, v56
    v_add_f32 v33, v33, v57
    v_add_f32 v34, v34, v58
    v_add_f32 v35, v35, v59
    s_waitcnt vmcnt(2)
    v_add_f32 v32, v32, v60
    v_add_f32 v33, v33, v61
    v_add_f32 v34, v34, v62
    v_add_f32 v35, v35, v63
    s_waitcnt vmcnt(1)
    v_add_f32 v32, v32, v64
    v_add_f32 v33, v33, v65
    v_add_f32 v34, v34, v66
    v_add_f32 v35, v35, v67
    s_waitcnt vmcnt(0)
    v_add_f32 v32, v32, v68
    v_add_f32 v33, v33, v69
    v_add_f32 v34, v34, v70
    v_add_f32 v35, v35, v71
    v_mov_b32 v36, 0
    v_mov_b32 v37, 0
    v_mov_b32 v38, 0
    v_mov_b32 v39, 0
    s_nop 1
    v_permlane32_swap_b32 v32, v36
    v_permlane32_swap_b32 v33, v37
    v_permlane32_swap_b32 v34, v38
    v_permlane32_swap_b32 v35, v39
    s_mov_b32 s29, 0xbfb8aa3b
    v_mul_f32 v40, s29, v32
    v_mul_f32 v41, s29, v33
    v_mul_f32 v42, s29, v34
    v_mul_f32 v43, s29, v35
    v_exp_f32 v40, v40
    v_exp_f32 v41, v41
    v_exp_f32 v42, v42
    v_exp_f32 v43, v43
    s_nop 0
    v_add_f32 v40, 1.0, v40
    v_add_f32 v41, 1.0, v41
    v_add_f32 v42, 1.0, v42
    v_add_f32 v43, 1.0, v43
    v_rcp_f32 v40, v40
    v_rcp_f32 v41, v41
    v_rcp_f32 v42, v42
    v_rcp_f32 v43, v43
    s_nop 0
    v_mul_f32 v40, v40, v32
    v_mul_f32 v41, v41, v33
    v_mul_f32 v42, v42, v34
    v_mul_f32 v43, v43, v35
    v_mul_f32 v40, v40, v36
    v_mul_f32 v41, v41, v37
    v_mul_f32 v42, v42, v38
    v_mul_f32 v43, v43, v39
    v_cvt_pk_bf16_f32 v40, v40, v41
    v_cvt_pk_bf16_f32 v41, v42, v43
    v_lshlrev_b32 v8, 3, v255
    v_add_u32 v8, 155648, v8
    s_mov_b32 exec_lo, -1
    s_mov_b32 exec_hi, 0
    ds_write_b64 v8, v[40:41]
    s_mov_b64 exec, -1
    v_and_b32 v8, 1, v255
    v_lshlrev_b32 v8, 7, v8
    v_lshl_add_u32 v8, v6, 4, v8
    v_add_u32 v8, 155648, v8
    s_waitcnt lgkmcnt(0)
    ds_read_b128 v[16:19], v8
    ds_read_b128 v[20:23], v8 offset:64
    v_mov_b32 v32, 0
    v_mov_b32 v33, 0
    v_mov_b32 v34, 0
    v_mov_b32 v35, 0
    v_mov_b32 v36, 0
    v_mov_b32 v37, 0
    v_mov_b32 v38, 0
    v_mov_b32 v39, 0
    v_mov_b32 v40, 0
    v_mov_b32 v41, 0
    v_mov_b32 v42, 0
    v_mov_b32 v43, 0
    v_mov_b32 v44, 0
    v_mov_b32 v45, 0
    v_mov_b32 v46, 0
    v_mov_b32 v47, 0
    ds_read_b64_tr_b16 v[64:65], v25 offset:0
    ds_read_b64_tr_b16 v[66:67], v25 offset:512
    ds_read_b64_tr_b16 v[68:69], v25 offset:32
    ds_read_b64_tr_b16 v[70:71], v25 offset:544
    ds_read_b64_tr_b16 v[72:73], v25 offset:64
    ds_read_b64_tr_b16 v[74:75], v25 offset:576
    ds_read_b64_tr_b16 v[76:77], v25 offset:96
    ds_read_b64_tr_b16 v[78:79], v25 offset:608
    s_waitcnt lgkmcnt(0)
    v_mfma_f32_16x16x32_bf16 v[32:35], v[16:19], v[64:67], v[32:35]
    v_mfma_f32_16x16x32_bf16 v[36:39], v[16:19], v[68:71], v[36:39]
    v_mfma_f32_16x16x32_bf16 v[40:43], v[16:19], v[72:75], v[40:43]
    v_mfma_f32_16x16x32_bf16 v[44:47], v[16:19], v[76:79], v[44:47]
    ds_read_b64_tr_b16 v[64:65], v25 offset:4096
    ds_read_b64_tr_b16 v[66:67], v25 offset:4608
    ds_read_b64_tr_b16 v[68:69], v25 offset:4128
    ds_read_b64_tr_b16 v[70:71], v25 offset:4640
    ds_read_b64_tr_b16 v[72:73], v25 offset:4160
    ds_read_b64_tr_b16 v[74:75], v25 offset:4672
    ds_read_b64_tr_b16 v[76:77], v25 offset:4192
    ds_read_b64_tr_b16 v[78:79], v25 offset:4704
    s_waitcnt lgkmcnt(0)
    v_mfma_f32_16x16x32_bf16 v[32:35], v[20:23], v[64:67], v[32:35]
    v_mfma_f32_16x16x32_bf16 v[36:39], v[20:23], v[68:71], v[36:39]
    v_mfma_f32_16x16x32_bf16 v[40:43], v[20:23], v[72:75], v[40:43]
    v_mfma_f32_16x16x32_bf16 v[44:47], v[20:23], v[76:79], v[44:47]
    v_lshlrev_b32 v8, 2, v255
    v_add_u32 v8, 156672, v8
    s_nop 7
    s_mov_b64 exec, 0xffff
    ds_write_b32 v8, v32 offset:0
    ds_write_b32 v8, v33 offset:256
    ds_write_b32 v8, v36 offset:64
    ds_write_b32 v8, v37 offset:320
    ds_write_b32 v8, v40 offset:128
    ds_write_b32 v8, v41 offset:384
    ds_write_b32 v8, v44 offset:192
    ds_write_b32 v8, v45 offset:448
    s_add_u32 s32, s24, 0xac4800
    s_addc_u32 s33, s25, 0
    s_mov_b32 s34, 0x1e000
    s_mov_b32 s35, 0x00020000
    s_mov_b32 exec_lo, -1
    s_mov_b32 exec_hi, 0
    v_add_u32 v8, 156672, v9
    s_waitcnt lgkmcnt(0)
    ds_read_b128 v[12:15], v8
    s_lshl_b32 s29, s2, 9
    s_waitcnt lgkmcnt(0)
    buffer_store_dwordx4 v[12:15], v9, s[32:35], s29 offen sc1
    s_mov_b64 exec, -1
    s_waitcnt vmcnt(0)
    s_add_u32 s52, s24, 0xa78800
    s_addc_u32 s53, s25, 0
    s_mov_b32 s54, 0x8000
    s_mov_b32 s55, 0x00020000
    s_lshl_b32 s29, s2, 7
    v_mov_b32 v10, s29
    v_mov_b32 v11, s26
    s_mov_b64 s[30:31], exec
    s_mov_b64 exec, 1
    buffer_store_dword v11, v10, s[52:55], 0 offen sc1
    s_mov_b64 exec, s[30:31]
    s_waitcnt vmcnt(0)
    s_endpgm
L_h_fin:
    v_mov_b32 v10, 163340
    s_mov_b32 s67, 1600000
L_y_go:
    ds_read_b32 v11, v10
    s_waitcnt lgkmcnt(0)
    v_readfirstlane_b32 s29, v11
    s_cmp_ge_u32 s29, 4
    s_cbranch_scc1 L_y_go_ok
    s_sleep 4
    s_sub_u32 s67, s67, 1
    s_cmp_lg_u32 s67, 0
    s_cbranch_scc1 L_y_go
L_y_go_ok:
    s_setprio 0
    s_sub_u32 s69, s2, 240
    s_add_u32 s40, s24, 0xa50700
    s_addc_u32 s41, s25, 0
    s_mov_b32 s42, 0x10
    s_mov_b32 s43, 0x00020000
    s_mov_b32 s67, 200000
    v_mov_b32 v5, 0
L_y_idx:
    buffer_load_dwordx4 v[8:11], v5, s[40:43], 0 offen sc1
    s_waitcnt vmcnt(0)
    v_readfirstlane_b32 s60, v8
    v_readfirstlane_b32 s29, v9
    v_readfirstlane_b32 s61, v10
    v_readfirstlane_b32 s30, v11
    s_xor_b32 s29, s29, s26
    s_xor_b32 s30, s30, s26
    s_or_b32 s29, s29, s30
    s_cmp_eq_u32 s29, 0
    s_cbranch_scc1 L_y_idx_ok
    s_sleep 8
    s_sub_u32 s67, s67, 1
    s_cmp_lg_u32 s67, 0
    s_cbranch_scc1 L_y_idx
L_y_idx_ok:
    s_add_u32 s36, s24, 0xa08600
    s_addc_u32 s37, s25, 0
    s_mov_b32 s38, 0x2000
    s_mov_b32 s39, 0x00020000
    v_lshrrev_b32 v6, 4, v255
    v_mov_b32 v8, s60
    v_mov_b32 v9, s61
    v_and_b32 v7, 1, v6
    v_cmp_eq_u32 vcc, 0, v7
    s_nop 1
    v_cndmask_b32 v8, v9, v8, vcc
    v_lshlrev_b32 v8, 2, v8
    buffer_load_dword v16, v8, s[36:39], 0 offen sc1
    s_add_u32 s40, s24, 0xa78800
    s_addc_u32 s41, s25, 0
    s_mov_b32 s42, 0x8000
    s_mov_b32 s43, 0x00020000
    v_min_u32 v5, 23, v255
    v_mul_u32_u24 v5, 10, v5
    v_add_u32 v5, s69, v5
    v_lshlrev_b32 v5, 7, v5
    s_mov_b32 s67, 200000
L_y_fd:
    buffer_load_dword v10, v5, s[40:43], 0 offen sc1
    s_waitcnt vmcnt(0)
    v_cmp_ne_u32 vcc, s26, v10
    s_cbranch_vccz L_y_fd_ok
    s_sleep 8
    s_sub_u32 s67, s67, 1
    s_cmp_lg_u32 s67, 0
    s_cbranch_scc1 L_y_fd
L_y_fd_ok:
    s_setprio 3
    s_add_u32 s32, s24, 0xac4800
    s_addc_u32 s33, s25, 0
    s_mov_b32 s34, 0x1e000
    s_mov_b32 s35, 0x00020000
    v_and_b32 v9, 31, v255
    v_lshlrev_b32 v9, 4, v9
    v_lshrrev_b32 v10, 5, v255
    v_mul_u32_u24 v10, 61440, v10
    v_add_u32 v9, v9, v10
    s_lshl_b32 s56, s69, 9
    buffer_load_dwordx4 v[32:35], v9, s[32:35], s56 offen sc1
    s_add_u32 s56, s56, 5120
    buffer_load_dwordx4 v[36:39], v9, s[32:35], s56 offen sc1
    s_add_u32 s56, s56, 5120
    buffer_load_dwordx4 v[40:43], v9, s[32:35], s56 offen sc1
    s_add_u32 s56, s56, 5120
    buffer_load_dwordx4 v[44:47], v9, s[32:35], s56 offen sc1
    s_add_u32 s56, s56, 5120
    buffer_load_dwordx4 v[48:51], v9, s[32:35], s56 offen sc1
    s_add_u32 s56, s56, 5120
    buffer_load_dwordx4 v[52:55], v9, s[32:35], s56 offen sc1
    s_add_u32 s56, s56, 5120
    buffer_load_dwordx4 v[56:59], v9, s[32:35], s56 offen sc1
    s_add_u32 s56, s56, 5120
    buffer_load_dwordx4 v[60:63], v9, s[32:35], s56 offen sc1
    s_add_u32 s56, s56, 5120
    buffer_load_dwordx4 v[64:67], v9, s[32:35], s56 offen sc1
    s_add_u32 s56, s56, 5120
    buffer_load_dwordx4 v[68:71], v9, s[32:35], s56 offen sc1
    s_add_u32 s56, s56, 5120
    buffer_load_dwordx4 v[72:75], v9, s[32:35], s56 offen sc1
    s_add_u32 s56, s56, 5120
    buffer_load_dwordx4 v[76:79], v9, s[32:35], s56 offen sc1
    s_mov_b32 s29, 0xbfb8aa3b
    v_mul_f32 v17, s29, v16
    v_exp_f32 v17, v17
    s_nop 0
    v_add_f32 v17, 1.0, v17
    v_rcp_f32 v17, v17
    s_nop 0
    s_waitcnt vmcnt(10)
    v_add_f32 v32, v32, v36
    v_add_f32 v33, v33, v37
    v_add_f32 v34, v34, v38
    v_add_f32 v35, v35, v39
    s_waitcnt vmcnt(9)
    v_add_f32 v32, v32, v40
    v_add_f32 v33, v33, v41
    v_add_f32 v34, v34, v42
    v_add_f32 v35, v35, v43
    s_waitcnt vmcnt(8)
    v_add_f32 v32, v32, v44
    v_add_f32 v33, v33, v45
    v_add_f32 v34, v34, v46
    v_add_f32 v35, v35, v47
    s_waitcnt vmcnt(7)
    v_add_f32 v32, v32, v48
    v_add_f32 v33, v33, v49
    v_add_f32 v34, v34, v50
    v_add_f32 v35, v35, v51
    s_waitcnt vmcnt(6)
    v_add_f32 v32, v32, v52
    v_add_f32 v33, v33, v53
    v_add_f32 v34, v34, v54
    v_add_f32 v35, v35, v55
    s_waitcnt vmcnt(5)
    v_add_f32 v32, v32, v56
    v_add_f32 v33, v33, v57
    v_add_f32 v34, v34, v58
    v_add_f32 v35, v35, v59
    s_waitcnt vmcnt(4)
    v_add_f32 v32, v32, v60
    v_add_f32 v33, v33, v61
    v_add_f32 v34, v34, v62
    v_add_f32 v35, v35, v63
    s_waitcnt vmcnt(3)
    v_add_f32 v32, v32, v64
    v_add_f32 v33, v33, v65
    v_add_f32 v34, v34, v66
    v_add_f32 v35, v35, v67
    s_waitcnt vmcnt(2)
    v_add_f32 v32, v32, v68
    v_add_f32 v33, v33, v69
    v_add_f32 v34, v34, v70
    v_add_f32 v35, v35, v71
    s_waitcnt vmcnt(1)
    v_add_f32 v32, v32, v72
    v_add_f32 v33, v33, v73
    v_add_f32 v34, v34, v74
    v_add_f32 v35, v35, v75
    s_waitcnt vmcnt(0)
    v_add_f32 v32, v32, v76
    v_add_f32 v33, v33, v77
    v_add_f32 v34, v34, v78
    v_add_f32 v35, v35, v79
    v_mov_b32 v36, 0
    v_mov_b32 v37, 0
    v_mov_b32 v38, 0
    v_mov_b32 v39, 0
    s_nop 1
    v_permlane32_swap_b32 v32, v36
    v_permlane32_swap_b32 v33, v37
    v_permlane32_swap_b32 v34, v38
    v_permlane32_swap_b32 v35, v39
    s_nop 1
    v_add_f32 v32, v32, v36
    v_add_f32 v33, v33, v37
    v_add_f32 v34, v34, v38
    v_add_f32 v35, v35, v39
    v_mul_f32 v32, v32, v17
    v_mul_f32 v33, v33, v17
    v_mul_f32 v34, v34, v17
    v_mul_f32 v35, v35, v17
    s_add_u32 s32, s24, 0xa4e700
    s_addc_u32 s33, s25, 0
    s_mov_b32 s34, 0x1400
    s_mov_b32 s35, 0x00020000
    v_and_b32 v8, 15, v255
    v_lshlrev_b32 v8, 4, v8
    v_mul_u32_u24 v7, 2560, v7
    v_add_u32 v8, v8, v7
    s_lshl_b32 s29, s69, 8
    s_mov_b32 exec_lo, -1
    s_mov_b32 exec_hi, 0
    buffer_store_dwordx4 v[32:35], v8, s[32:35], s29 offen sc1
    s_mov_b64 exec, -1
    s_waitcnt vmcnt(0)
    s_add_u32 s52, s24, 0xa80800
    s_addc_u32 s53, s25, 0
    s_mov_b32 s54, 0x8000
    s_mov_b32 s55, 0x00020000
    s_lshl_b32 s29, s69, 7
    v_mov_b32 v10, s29
    v_mov_b32 v11, s26
    s_mov_b64 s[30:31], exec
    s_mov_b64 exec, 1
    buffer_store_dword v11, v10, s[52:55], 0 offen sc1
    s_mov_b64 exec, s[30:31]
    s_waitcnt vmcnt(0)
L_end:
    s_endpgm
.section .rodata,"a"
.p2align 6
.amdhsa_kernel parallel_sum__mha_block__moe_arch_mod__prompt_kernel
  .amdhsa_next_free_vgpr 256
  .amdhsa_next_free_sgpr 102
  .amdhsa_accum_offset 256
  .amdhsa_group_segment_fixed_size 0
  .amdhsa_kernarg_size 88
  .amdhsa_user_sgpr_count 2
  .amdhsa_user_sgpr_kernarg_segment_ptr 1
  .amdhsa_system_sgpr_workgroup_id_x 1
  .amdhsa_float_denorm_mode_32 3
.end_amdhsa_kernel
```
